```python
import torch

def _softmax(x, axis=-1):
    return torch.softmax(x, dim=axis)
def _gelu(x):
    return torch.nn.functional.gelu(x, approximate="tanh")
def _silu(x):
    return torch.nn.functional.silu(x)
def _sigmoid(x):
    return torch.sigmoid(x)
def _layernorm(x, axis=-1, eps=1e-5):
    m = x.mean(dim=axis, keepdim=True)
    v = x.var(dim=axis, keepdim=True, unbiased=False)
    return (x - m) / torch.sqrt(v + eps)
def _scatter_add(tgt, idx, src, axis=0):
    return tgt.clone().index_add_(axis, idx, src)
def _segment_sum(src, seg, n):
    out = torch.zeros((n,) + src.shape[1:], dtype=src.dtype)
    return out.index_add_(0, seg, src)
def _pad(x, pw):
    flat = tuple(v for pair in reversed(pw) for v in pair)
    return torch.nn.functional.pad(x, flat)

kernel_name = 'parallel_sum__grouped_kv_mqa__dense_activation_squared_relu__prompt'

def setup_inputs():

    _w = (lambda a: (lambda t: t.to(torch.bfloat16) if t.is_floating_point() else t)(torch.as_tensor(a)))
    def _A_setup():
        B, S, D, H = 1, 2048, 640, 32
        Dh = D // H
        return {
            "x": _w((lambda *s: torch.randn(*s, dtype=torch.bfloat16) * 0.05)(B, S, D)),
            "wq": _w((lambda *s: torch.randn(*s, dtype=torch.bfloat16) * 0.2)(D, H * Dh)),
            "wk": _w((lambda *s: torch.randn(*s, dtype=torch.bfloat16) * 0.2)(D, Dh)),
            "wv": _w((lambda *s: torch.randn(*s, dtype=torch.bfloat16) * 0.1)(D, Dh)),
            "wo": _w((lambda *s: torch.randn(*s, dtype=torch.bfloat16) * 0.1)(H * Dh, D)),
        }
    _A_in = _A_setup()

    def _B_setup():
        B, S, D, F = 1, 2048, 640, 1728
        return {
            "x": _w((lambda *s: torch.randn(*s, dtype=torch.bfloat16) * 0.05)(B, S, D)),
            "w1": _w((lambda *s: torch.randn(*s, dtype=torch.bfloat16) * 0.1)(D, F)),
            "b1": _w((lambda *s: torch.randn(*s, dtype=torch.bfloat16) * 0.4)(F)),
            "w2": _w((lambda *s: torch.randn(*s, dtype=torch.bfloat16) * 0.1)(F, D)),
            "b2": _w((lambda *s: torch.randn(*s, dtype=torch.bfloat16) * 12.8)(D)),
        }
    _B_in = _B_setup()

    return {
        "A_x": _A_in["x"],
        "A_wq": _A_in["wq"],
        "A_wk": _A_in["wk"],
        "A_wv": _A_in["wv"],
        "A_wo": _A_in["wo"],
        "B_x": _B_in["x"],
        "B_w1": _B_in["w1"],
        "B_b1": _B_in["b1"],
        "B_w2": _B_in["w2"],
        "B_b2": _B_in["b2"],
    }

def reference(A_x, A_wq, A_wk, A_wv, A_wo, B_x, B_w1, B_b1, B_w2, B_b2):
    def _A_ref(x, wq, wk, wv, wo):
        B, S, D = x.shape
        H = 32
        Dh = D // H
        q = (lambda x, *d: x.permute(*d))((x @ wq).reshape(B, S, H, Dh), 0, 2, 1, 3)
        k = x @ wk
        v = x @ wv
        scores = torch.einsum("bhqd,bkd->bhqk", q, k) * (Dh ** -0.5)
        p = _softmax(scores, axis=-1)
        o = torch.einsum("bhqk,bkd->bhqd", p, v)
        return (lambda x, *d: x.permute(*d))(o, 0, 2, 1, 3).reshape(B, S, H * Dh) @ wo

    def _B_ref(x, w1, b1, w2, b2):
        h = torch.einsum("bsd,df->bsf", x, w1) + b1
        zero = torch.zeros_like(h)
        r = torch.where(h > zero, h, zero)
        h = r * r
        out = torch.einsum("bsf,fd->bsd", h, w2) + b2
        return out

    x = A_x
    xn = _layernorm(x, axis=-1)
    return x + _A_ref(xn, A_wq, A_wk, A_wv, A_wo) + _B_ref(xn, B_w1, B_b1, B_w2, B_b2)
```

```asm
; @launch grid=(256,1,1) block=(768,1,1) lds=163840
.amdgcn_target "amdgcn-amd-amdhsa--gfx950"
.text
.globl parallel_sum__grouped_kv_mqa__dense_activation_squared_relu__prompt_kernel
.p2align 8
.type parallel_sum__grouped_kv_mqa__dense_activation_squared_relu__prompt_kernel,@function
parallel_sum__grouped_kv_mqa__dense_activation_squared_relu__prompt_kernel:
    s_cmp_ge_u32 s2, 256
    s_cbranch_scc1 F_END
    s_load_dwordx16 s[4:19], s[0:1], 0
    s_load_dwordx8 s[20:27], s[0:1], 64
    s_load_dwordx2 s[28:29], s[0:1], 96
    s_and_b32 s48, s2, 3
    s_lshl_b32 s48, s48, 3
    s_bfe_u32 s52, s2, 0x30003
    s_add_u32 s48, s48, s52
    s_and_b32 s49, s2, 4
    s_lshr_b32 s53, s2, 6
    s_add_u32 s49, s49, s53
    s_lshl_b32 s53, s53, 1
    s_add_u32 s51, s52, s53
    s_and_b32 s51, s51, 7
    v_lshrrev_b32 v2, 6, v0
    v_and_b32 v1, 63, v0
    v_readfirstlane_b32 s50, v2
    v_and_b32 v6, 31, v0
    v_lshrrev_b32 v7, 5, v1
    v_mov_b32 v12, 162816
    v_lshlrev_b32 v13, 20, v1
    v_add_u32 v13, 162816, v13
    s_mul_i32 s62, s51, 5
    s_lshr_b32 s62, s62, 2
    v_lshlrev_b32 v3, 2, v1
    v_mov_b32 v2, 0
    v_add_u32 v3, 163088, v3
    ds_write_b32 v3, v2
    s_waitcnt lgkmcnt(0)
    s_barrier
    s_mov_b32 s44, s28
    s_mov_b32 s45, s29
    s_mov_b32 s46, 33554432
    s_mov_b32 s47, 0x20000
    s_and_b32 s14, s2, 3
    s_lshl_b32 s14, s14, 2
    s_bfe_u32 s52, s2, 0x10002
    s_lshl_b32 s52, s52, 1
    s_add_u32 s14, s14, s52
    s_cmp_ge_u32 s50, 8
    s_cbranch_scc1 F_GEMM
    s_mov_b32 s32, s4
    s_mov_b32 s33, s5
    s_mov_b32 s34, 2621440
    s_mov_b32 s35, 0x20000
    v_lshrrev_b32 v2, 3, v1
    v_and_b32 v3, 7, v1
    s_and_b32 s72, s49, 1
    s_lshl_b32 s72, s72, 2
    s_xor_b32 s72, s72, s50
    s_and_b32 s52, s49, 2
    s_xor_b32 s72, s72, s52
    s_lshl_b32 s52, s48, 6
    s_lshl_b32 s53, s72, 3
    s_add_u32 s52, s52, s53
    s_mul_i32 s52, s52, 1280
    v_mul_u32_u24 v160, 1280, v2
    v_lshl_add_u32 v160, v3, 4, v160
    s_lshl_b32 s53, s62, 7
    s_add_u32 s64, s52, s53
    s_add_u32 s65, s52, 1280
    v_mov_b32 v22, 1
    s_cmp_ge_u32 s50, 4
    s_cbranch_scc1 A_SET
    buffer_load_dwordx4 v[40:43], v160, s[32:35], s64 offen
    s_add_u32 s64, s64, 128
    s_cmp_eq_u32 s64, s65
    s_cselect_b32 s53, 1280, 0
    s_sub_u32 s64, s64, s53
    buffer_load_dwordx4 v[44:47], v160, s[32:35], s64 offen
    s_add_u32 s64, s64, 128
    s_cmp_eq_u32 s64, s65
    s_cselect_b32 s53, 1280, 0
    s_sub_u32 s64, s64, s53
    buffer_load_dwordx4 v[48:51], v160, s[32:35], s64 offen
    s_add_u32 s64, s64, 128
    s_cmp_eq_u32 s64, s65
    s_cselect_b32 s53, 1280, 0
    s_sub_u32 s64, s64, s53
    buffer_load_dwordx4 v[52:55], v160, s[32:35], s64 offen
    s_add_u32 s64, s64, 128
    s_cmp_eq_u32 s64, s65
    s_cselect_b32 s53, 1280, 0
    s_sub_u32 s64, s64, s53
    buffer_load_dwordx4 v[56:59], v160, s[32:35], s64 offen
    s_add_u32 s64, s64, 128
    s_cmp_eq_u32 s64, s65
    s_cselect_b32 s53, 1280, 0
    s_sub_u32 s64, s64, s53
    buffer_load_dwordx4 v[60:63], v160, s[32:35], s64 offen
    s_add_u32 s64, s64, 128
    s_cmp_eq_u32 s64, s65
    s_cselect_b32 s53, 1280, 0
    s_sub_u32 s64, s64, s53
    buffer_load_dwordx4 v[64:67], v160, s[32:35], s64 offen
    s_add_u32 s64, s64, 128
    s_cmp_eq_u32 s64, s65
    s_cselect_b32 s53, 1280, 0
    s_sub_u32 s64, s64, s53
    buffer_load_dwordx4 v[68:71], v160, s[32:35], s64 offen
    s_add_u32 s64, s64, 128
    s_cmp_eq_u32 s64, s65
    s_cselect_b32 s53, 1280, 0
    s_sub_u32 s64, s64, s53
    buffer_load_dwordx4 v[72:75], v160, s[32:35], s64 offen
    s_add_u32 s64, s64, 128
    s_cmp_eq_u32 s64, s65
    s_cselect_b32 s53, 1280, 0
    s_sub_u32 s64, s64, s53
    buffer_load_dwordx4 v[76:79], v160, s[32:35], s64 offen
    ds_add_u32 v13, v22 offset:344
A_SET:
    s_and_b32 s52, s72, 3
    s_lshl_b32 s52, s52, 3
    v_add_u32 v4, s52, v2
    v_xor_b32 v4, v4, v3
    v_lshlrev_b32 v4, 4, v4
    v_lshl_add_u32 v4, v3, 9, v4
    s_lshr_b32 s15, s72, 2
    s_mul_i32 s55, s15, 40960
    s_add_u32 s55, s55, 45056
    v_add_u32 v21, s55, v4
    s_lshl_b32 s52, s72, 5
    s_add_u32 s52, s52, 162816
    v_lshlrev_b32 v14, 2, v2
    v_add_u32 v14, s52, v14
    v_add_u32 v2, 0, v7
    v_xor_b32 v2, v2, v6
    v_lshlrev_b32 v2, 4, v2
    v_lshl_add_u32 v2, v7, 9, v2
    v_add_u32 v8, s55, v2
    v_add_u32 v2, 2, v7
    v_xor_b32 v2, v2, v6
    v_lshlrev_b32 v2, 4, v2
    v_lshl_add_u32 v2, v7, 9, v2
    v_add_u32 v9, s55, v2
    v_add_u32 v2, 4, v7
    v_xor_b32 v2, v2, v6
    v_lshlrev_b32 v2, 4, v2
    v_lshl_add_u32 v2, v7, 9, v2
    v_add_u32 v10, s55, v2
    v_add_u32 v2, 6, v7
    v_xor_b32 v2, v2, v6
    v_lshlrev_b32 v2, 4, v2
    v_lshl_add_u32 v2, v7, 9, v2
    v_add_u32 v11, s55, v2
    v_bfe_u32 v2, v1, 2, 2
    v_lshlrev_b32 v2, 1, v2
    v_lshl_add_u32 v2, v7, 3, v2
    v_bfe_u32 v3, v1, 4, 1
    v_and_b32 v5, 3, v1
    v_lshl_add_u32 v3, v3, 2, v5
    v_and_b32 v4, 1, v3
    v_lshlrev_b32 v4, 1, v4
    v_bfe_u32 v5, v3, 1, 1
    v_or_b32 v4, v4, v5
    v_and_b32 v3, 4, v3
    v_or_b32 v3, v3, v4
    v_cmp_lt_u32 vcc, 4, v3
    v_and_b32 v4, 1, v3
    v_lshlrev_b32 v4, 17, v4
    v_min_u32 v3, 4, v3
    v_cndmask_b32 v4, 0, v4, vcc
    v_add_u32 v3, v3, v4
    v_mul_u32_u24 v2, 160, v2
    v_lshl_add_u32 v2, v3, 3, v2
    s_and_b32 s52, s50, 3
    s_mul_i32 s52, s52, 40
    v_add_u32 v15, s52, v2
    v_add_u32 v16, 126976, v15
    s_mov_b32 s66, 0x3f803f80
    s_mov_b32 s67, 0x00003f80
    s_mov_b32 s68, 0x3f800000
    v_mov_b32 v17, 0
    v_mov_b32 v18, 0
    v_mov_b32 v19, 0
    v_mov_b32 v20, 0
    s_cmp_lt_u32 s50, 4
    s_cselect_b32 s69, 255, -1
    s_cselect_b32 s70, 4, 1024
    s_cselect_b32 s52, 1, 256
    v_mov_b32 v140, s52
    s_sub_u32 s54, s50, 4
    s_add_u32 s58, s14, s54
    s_and_b32 s58, s58, 15
    s_lshl_b32 s59, s58, 10
    s_cmp_eq_u32 s54, 2
    s_cselect_b32 s59, 0x4000, s59
    s_cselect_b32 s52, 63, 3
    s_add_u32 s59, s59, 20971520
    s_cmp_lt_u32 s54, 3
    s_cselect_b32 s59, s59, 1073741824
    s_mul_i32 s58, s58, 11264
    v_and_b32 v142, s52, v1
    v_lshlrev_b32 v142, 8, v142
    s_mul_i32 s60, s54, 11264
    s_mov_b32 s61, 0
    s_mov_b32 s40, s6
    s_mov_b32 s41, s7
    s_mov_b32 s42, 819200
    s_mov_b32 s43, 0x20000
    s_add_u32 s36, s28, 2621440
    s_addc_u32 s37, s29, 0
    s_mov_b32 s38, 180224
    s_mov_b32 s39, 0x20000
    s_mul_i32 s52, s49, 160
    v_add_u32 v2, 0, v1
    v_mul_u32_u24 v3, 6554, v2
    v_lshrrev_b32 v3, 16, v3
    v_mul_u32_u24 v4, 10, v3
    v_sub_u32 v4, v2, v4
    v_mul_u32_u24 v3, 1280, v3
    v_lshl_add_u32 v3, v4, 4, v3
    v_add_u32 v161, s52, v3
    v_add_u32 v2, 64, v1
    v_mul_u32_u24 v3, 6554, v2
    v_lshrrev_b32 v3, 16, v3
    v_mul_u32_u24 v4, 10, v3
    v_sub_u32 v4, v2, v4
    v_mul_u32_u24 v3, 1280, v3
    v_lshl_add_u32 v3, v4, 4, v3
    v_add_u32 v162, s52, v3
    v_add_u32 v2, 128, v1
    v_mul_u32_u24 v3, 6554, v2
    v_lshrrev_b32 v3, 16, v3
    v_mul_u32_u24 v4, 10, v3
    v_sub_u32 v4, v2, v4
    v_mul_u32_u24 v3, 1280, v3
    v_lshl_add_u32 v3, v4, 4, v3
    v_add_u32 v163, s52, v3
    v_add_u32 v2, 192, v1
    v_mul_u32_u24 v3, 6554, v2
    v_lshrrev_b32 v3, 16, v3
    v_mul_u32_u24 v4, 10, v3
    v_sub_u32 v4, v2, v4
    v_mul_u32_u24 v3, 1280, v3
    v_lshl_add_u32 v3, v4, 4, v3
    v_add_u32 v164, s52, v3
    v_add_u32 v2, 256, v1
    v_mul_u32_u24 v3, 6554, v2
    v_lshrrev_b32 v3, 16, v3
    v_mul_u32_u24 v4, 10, v3
    v_sub_u32 v4, v2, v4
    v_mul_u32_u24 v3, 1280, v3
    v_lshl_add_u32 v3, v4, 4, v3
    v_add_u32 v165, s52, v3
    s_and_b32 s52, s50, 3
    s_add_u32 s71, s62, s52
    s_add_u32 s71, s71, 6
    s_cmp_ge_u32 s71, 10
    s_cselect_b32 s53, 10, 0
    s_sub_u32 s71, s71, s53
    s_mul_i32 s71, s71, 81920
    s_add_u32 s57, s52, 1
    s_mul_i32 s57, s57, 11264
    s_cmp_eq_u32 s52, 3
    s_cselect_b32 s57, 126976, s57
    v_lshlrev_b32 v136, 4, v1
    v_add_u32 v141, s57, v136
    s_lshl_b32 s53, s52, 2
    v_add_u32 v167, s53, v13
    v_add_u32 v113, s53, v12
    s_mul_i32 s57, s52, 1536
    s_add_u32 s57, s57, 137216
    s_add_u32 s52, s52, 1
    s_lshr_b32 s52, s52, 1
    s_lshl_b32 s52, s52, 2
    v_add_u32 v166, s52, v12
    v_lshlrev_b32 v137, 3, v1
    v_mul_u32_u24 v138, 384, v7
    v_min_u32 v4, 21, v6
    v_lshl_add_u32 v138, v4, 4, v138
    v_lshlrev_b32 v139, 4, v0
    v_mov_b32 v126, 0x3f803f80
    v_mov_b32 v127, 0
    v_mov_b32 v154, 0
    v_mov_b32 v155, 0
    v_mov_b32 v158, 0
    v_mov_b32 v159, 0
    v_mov_b32 v108, 0
    v_mov_b32 v109, 0
    v_mov_b32 v132, 0
    v_mov_b32 v133, 0
    v_mov_b32 v134, 0
    v_mov_b32 v135, 0
    v_mov_b32 v116, 0
    v_mov_b32 v117, 0
    v_mov_b32 v118, 0
    v_mov_b32 v119, 0
    s_lshl_b32 s52, s15, 7
    s_add_u32 s52, s52, 162816
    v_lshlrev_b32 v143, 2, v6
    v_add_u32 v143, s52, v143
    s_cmp_lt_u32 s50, 4
    s_cbranch_scc1 A_LN
    buffer_load_dwordx4 v[40:43], v160, s[32:35], s64 offen
    s_add_u32 s64, s64, 128
    s_cmp_eq_u32 s64, s65
    s_cselect_b32 s53, 1280, 0
    s_sub_u32 s64, s64, s53
    buffer_load_dwordx4 v[44:47], v160, s[32:35], s64 offen
    s_add_u32 s64, s64, 128
    s_cmp_eq_u32 s64, s65
    s_cselect_b32 s53, 1280, 0
    s_sub_u32 s64, s64, s53
    buffer_load_dwordx4 v[48:51], v160, s[32:35], s64 offen
    s_add_u32 s64, s64, 128
    s_cmp_eq_u32 s64, s65
    s_cselect_b32 s53, 1280, 0
    s_sub_u32 s64, s64, s53
    buffer_load_dwordx4 v[52:55], v160, s[32:35], s64 offen
    s_add_u32 s64, s64, 128
    s_cmp_eq_u32 s64, s65
    s_cselect_b32 s53, 1280, 0
    s_sub_u32 s64, s64, s53
    buffer_load_dwordx4 v[56:59], v160, s[32:35], s64 offen
    s_add_u32 s64, s64, 128
    s_cmp_eq_u32 s64, s65
    s_cselect_b32 s53, 1280, 0
    s_sub_u32 s64, s64, s53
    buffer_load_dwordx4 v[60:63], v160, s[32:35], s64 offen
    s_add_u32 s64, s64, 128
    s_cmp_eq_u32 s64, s65
    s_cselect_b32 s53, 1280, 0
    s_sub_u32 s64, s64, s53
    buffer_load_dwordx4 v[64:67], v160, s[32:35], s64 offen
    s_add_u32 s64, s64, 128
    s_cmp_eq_u32 s64, s65
    s_cselect_b32 s53, 1280, 0
    s_sub_u32 s64, s64, s53
    buffer_load_dwordx4 v[68:71], v160, s[32:35], s64 offen
    s_add_u32 s64, s64, 128
    s_cmp_eq_u32 s64, s65
    s_cselect_b32 s53, 1280, 0
    s_sub_u32 s64, s64, s53
    buffer_load_dwordx4 v[72:75], v160, s[32:35], s64 offen
    s_add_u32 s64, s64, 128
    s_cmp_eq_u32 s64, s65
    s_cselect_b32 s53, 1280, 0
    s_sub_u32 s64, s64, s53
    buffer_load_dwordx4 v[76:79], v160, s[32:35], s64 offen
    ds_add_u32 v13, v22 offset:344
A_LN:
    s_setprio 3
    s_waitcnt vmcnt(9)
    v_dot2_f32_bf16 v17, v40, s66, v17
    v_dot2_f32_bf16 v18, v41, s66, v18
    v_dot2_f32_bf16 v17, v42, s66, v17
    v_dot2_f32_bf16 v18, v43, s66, v18
    s_waitcnt vmcnt(8)
    v_dot2_f32_bf16 v17, v44, s66, v17
    v_dot2_f32_bf16 v18, v45, s66, v18
    v_dot2_f32_bf16 v17, v46, s66, v17
    v_dot2_f32_bf16 v18, v47, s66, v18
    s_waitcnt vmcnt(7)
    v_dot2_f32_bf16 v17, v48, s66, v17
    v_dot2_f32_bf16 v18, v49, s66, v18
    v_dot2_f32_bf16 v17, v50, s66, v17
    v_dot2_f32_bf16 v18, v51, s66, v18
    s_waitcnt vmcnt(6)
    v_dot2_f32_bf16 v17, v52, s66, v17
    v_dot2_f32_bf16 v18, v53, s66, v18
    v_dot2_f32_bf16 v17, v54, s66, v17
    v_dot2_f32_bf16 v18, v55, s66, v18
    s_waitcnt vmcnt(5)
    v_dot2_f32_bf16 v17, v56, s66, v17
    v_dot2_f32_bf16 v18, v57, s66, v18
    v_dot2_f32_bf16 v17, v58, s66, v17
    v_dot2_f32_bf16 v18, v59, s66, v18
    s_waitcnt vmcnt(4)
    v_dot2_f32_bf16 v17, v60, s66, v17
    v_dot2_f32_bf16 v18, v61, s66, v18
    v_dot2_f32_bf16 v17, v62, s66, v17
    v_dot2_f32_bf16 v18, v63, s66, v18
    s_waitcnt vmcnt(3)
    v_dot2_f32_bf16 v17, v64, s66, v17
    v_dot2_f32_bf16 v18, v65, s66, v18
    v_dot2_f32_bf16 v17, v66, s66, v17
    v_dot2_f32_bf16 v18, v67, s66, v18
    s_waitcnt vmcnt(2)
    v_dot2_f32_bf16 v17, v68, s66, v17
    v_dot2_f32_bf16 v18, v69, s66, v18
    v_dot2_f32_bf16 v17, v70, s66, v17
    v_dot2_f32_bf16 v18, v71, s66, v18
    s_waitcnt vmcnt(1)
    v_dot2_f32_bf16 v17, v72, s66, v17
    v_dot2_f32_bf16 v18, v73, s66, v18
    v_dot2_f32_bf16 v17, v74, s66, v17
    v_dot2_f32_bf16 v18, v75, s66, v18
    s_waitcnt vmcnt(0)
    v_dot2_f32_bf16 v17, v76, s66, v17
    v_dot2_f32_bf16 v18, v77, s66, v18
    v_dot2_f32_bf16 v17, v78, s66, v17
    v_dot2_f32_bf16 v18, v79, s66, v18
    s_nop 2
    v_add_f32 v17, v17, v18
    s_nop 1
    v_add_f32_dpp v17, v17, v17 quad_perm:[1,0,3,2] row_mask:0xf bank_mask:0xf
    s_nop 1
    v_add_f32_dpp v17, v17, v17 quad_perm:[2,3,0,1] row_mask:0xf bank_mask:0xf
    s_nop 1
    v_add_f32_dpp v17, v17, v17 row_half_mirror row_mask:0xf bank_mask:0xf
    v_mul_f32 v17, 0xbacccccd, v17
    v_dot2_f32_bf16 v80, v40, s67, v17
    v_dot2_f32_bf16 v81, v40, s68, v17
    v_dot2_f32_bf16 v82, v41, s67, v17
    v_dot2_f32_bf16 v83, v41, s68, v17
    v_dot2_f32_bf16 v84, v42, s67, v17
    v_dot2_f32_bf16 v85, v42, s68, v17
    v_dot2_f32_bf16 v86, v43, s67, v17
    v_dot2_f32_bf16 v87, v43, s68, v17
    v_cvt_pk_bf16_f32 v40, v80, v82
    v_cvt_pk_bf16_f32 v42, v81, v83
    v_cvt_pk_bf16_f32 v41, v84, v86
    v_cvt_pk_bf16_f32 v43, v85, v87
    ds_write_b128 v21, v[40:43] offset:0
    v_dot2_f32_bf16 v80, v44, s67, v17
    v_dot2_f32_bf16 v81, v44, s68, v17
    v_dot2_f32_bf16 v82, v45, s67, v17
    v_dot2_f32_bf16 v83, v45, s68, v17
    v_dot2_f32_bf16 v84, v46, s67, v17
    v_dot2_f32_bf16 v85, v46, s68, v17
    v_dot2_f32_bf16 v86, v47, s67, v17
    v_dot2_f32_bf16 v87, v47, s68, v17
    v_cvt_pk_bf16_f32 v44, v80, v82
    v_cvt_pk_bf16_f32 v46, v81, v83
    v_cvt_pk_bf16_f32 v45, v84, v86
    v_cvt_pk_bf16_f32 v47, v85, v87
    ds_write_b128 v21, v[44:47] offset:4096
    v_dot2_f32_bf16 v80, v48, s67, v17
    v_dot2_f32_bf16 v81, v48, s68, v17
    v_dot2_f32_bf16 v82, v49, s67, v17
    v_dot2_f32_bf16 v83, v49, s68, v17
    v_dot2_f32_bf16 v84, v50, s67, v17
    v_dot2_f32_bf16 v85, v50, s68, v17
    v_dot2_f32_bf16 v86, v51, s67, v17
    v_dot2_f32_bf16 v87, v51, s68, v17
    v_cvt_pk_bf16_f32 v48, v80, v82
    v_cvt_pk_bf16_f32 v50, v81, v83
    v_cvt_pk_bf16_f32 v49, v84, v86
    v_cvt_pk_bf16_f32 v51, v85, v87
    ds_write_b128 v21, v[48:51] offset:8192
    v_dot2_f32_bf16 v80, v52, s67, v17
    v_dot2_f32_bf16 v81, v52, s68, v17
    v_dot2_f32_bf16 v82, v53, s67, v17
    v_dot2_f32_bf16 v83, v53, s68, v17
    v_dot2_f32_bf16 v84, v54, s67, v17
    v_dot2_f32_bf16 v85, v54, s68, v17
    v_dot2_f32_bf16 v86, v55, s67, v17
    v_dot2_f32_bf16 v87, v55, s68, v17
    v_cvt_pk_bf16_f32 v52, v80, v82
    v_cvt_pk_bf16_f32 v54, v81, v83
    v_cvt_pk_bf16_f32 v53, v84, v86
    v_cvt_pk_bf16_f32 v55, v85, v87
    ds_write_b128 v21, v[52:55] offset:12288
    v_dot2_f32_bf16 v80, v56, s67, v17
    v_dot2_f32_bf16 v81, v56, s68, v17
    v_dot2_f32_bf16 v82, v57, s67, v17
    v_dot2_f32_bf16 v83, v57, s68, v17
    v_dot2_f32_bf16 v84, v58, s67, v17
    v_dot2_f32_bf16 v85, v58, s68, v17
    v_dot2_f32_bf16 v86, v59, s67, v17
    v_dot2_f32_bf16 v87, v59, s68, v17
    v_cvt_pk_bf16_f32 v56, v80, v82
    v_cvt_pk_bf16_f32 v58, v81, v83
    v_cvt_pk_bf16_f32 v57, v84, v86
    v_cvt_pk_bf16_f32 v59, v85, v87
    ds_write_b128 v21, v[56:59] offset:16384
    v_dot2_f32_bf16 v80, v60, s67, v17
    v_dot2_f32_bf16 v81, v60, s68, v17
    v_dot2_f32_bf16 v82, v61, s67, v17
    v_dot2_f32_bf16 v83, v61, s68, v17
    v_dot2_f32_bf16 v84, v62, s67, v17
    v_dot2_f32_bf16 v85, v62, s68, v17
    v_dot2_f32_bf16 v86, v63, s67, v17
    v_dot2_f32_bf16 v87, v63, s68, v17
    v_cvt_pk_bf16_f32 v60, v80, v82
    v_cvt_pk_bf16_f32 v62, v81, v83
    v_cvt_pk_bf16_f32 v61, v84, v86
    v_cvt_pk_bf16_f32 v63, v85, v87
    ds_write_b128 v21, v[60:63] offset:20480
    v_dot2_f32_bf16 v80, v64, s67, v17
    v_dot2_f32_bf16 v81, v64, s68, v17
    v_dot2_f32_bf16 v82, v65, s67, v17
    v_dot2_f32_bf16 v83, v65, s68, v17
    v_dot2_f32_bf16 v84, v66, s67, v17
    v_dot2_f32_bf16 v85, v66, s68, v17
    v_dot2_f32_bf16 v86, v67, s67, v17
    v_dot2_f32_bf16 v87, v67, s68, v17
    v_cvt_pk_bf16_f32 v64, v80, v82
    v_cvt_pk_bf16_f32 v66, v81, v83
    v_cvt_pk_bf16_f32 v65, v84, v86
    v_cvt_pk_bf16_f32 v67, v85, v87
    ds_write_b128 v21, v[64:67] offset:24576
    v_dot2_f32_bf16 v80, v68, s67, v17
    v_dot2_f32_bf16 v81, v68, s68, v17
    v_dot2_f32_bf16 v82, v69, s67, v17
    v_dot2_f32_bf16 v83, v69, s68, v17
    v_dot2_f32_bf16 v84, v70, s67, v17
    v_dot2_f32_bf16 v85, v70, s68, v17
    v_dot2_f32_bf16 v86, v71, s67, v17
    v_dot2_f32_bf16 v87, v71, s68, v17
    v_cvt_pk_bf16_f32 v68, v80, v82
    v_cvt_pk_bf16_f32 v70, v81, v83
    v_cvt_pk_bf16_f32 v69, v84, v86
    v_cvt_pk_bf16_f32 v71, v85, v87
    ds_write_b128 v21, v[68:71] offset:28672
    v_dot2_f32_bf16 v80, v72, s67, v17
    v_dot2_f32_bf16 v81, v72, s68, v17
    v_dot2_f32_bf16 v82, v73, s67, v17
    v_dot2_f32_bf16 v83, v73, s68, v17
    v_dot2_f32_bf16 v84, v74, s67, v17
    v_dot2_f32_bf16 v85, v74, s68, v17
    v_dot2_f32_bf16 v86, v75, s67, v17
    v_dot2_f32_bf16 v87, v75, s68, v17
    v_cvt_pk_bf16_f32 v72, v80, v82
    v_cvt_pk_bf16_f32 v74, v81, v83
    v_cvt_pk_bf16_f32 v73, v84, v86
    v_cvt_pk_bf16_f32 v75, v85, v87
    ds_write_b128 v21, v[72:75] offset:32768
    v_dot2_f32_bf16 v80, v76, s67, v17
    v_dot2_f32_bf16 v81, v76, s68, v17
    v_dot2_f32_bf16 v82, v77, s67, v17
    v_dot2_f32_bf16 v83, v77, s68, v17
    v_dot2_f32_bf16 v84, v78, s67, v17
    v_dot2_f32_bf16 v85, v78, s68, v17
    v_dot2_f32_bf16 v86, v79, s67, v17
    v_dot2_f32_bf16 v87, v79, s68, v17
    v_cvt_pk_bf16_f32 v76, v80, v82
    v_cvt_pk_bf16_f32 v78, v81, v83
    v_cvt_pk_bf16_f32 v77, v84, v86
    v_cvt_pk_bf16_f32 v79, v85, v87
    ds_write_b128 v21, v[76:79] offset:36864
    ds_add_u32 v13, v140 offset:336
    s_setprio 1
    v_dot2_f32_bf16 v19, v40, v40, v19
    v_dot2_f32_bf16 v20, v41, v41, v20
    v_dot2_f32_bf16 v19, v42, v42, v19
    v_dot2_f32_bf16 v20, v43, v43, v20
    v_dot2_f32_bf16 v19, v44, v44, v19
    v_dot2_f32_bf16 v20, v45, v45, v20
    v_dot2_f32_bf16 v19, v46, v46, v19
    v_dot2_f32_bf16 v20, v47, v47, v20
    v_dot2_f32_bf16 v19, v48, v48, v19
    v_dot2_f32_bf16 v20, v49, v49, v20
    v_dot2_f32_bf16 v19, v50, v50, v19
    v_dot2_f32_bf16 v20, v51, v51, v20
    v_dot2_f32_bf16 v19, v52, v52, v19
    v_dot2_f32_bf16 v20, v53, v53, v20
    v_dot2_f32_bf16 v19, v54, v54, v19
    v_dot2_f32_bf16 v20, v55, v55, v20
    v_dot2_f32_bf16 v19, v56, v56, v19
    v_dot2_f32_bf16 v20, v57, v57, v20
    v_dot2_f32_bf16 v19, v58, v58, v19
    v_dot2_f32_bf16 v20, v59, v59, v20
    v_dot2_f32_bf16 v19, v60, v60, v19
    v_dot2_f32_bf16 v20, v61, v61, v20
    v_dot2_f32_bf16 v19, v62, v62, v19
    v_dot2_f32_bf16 v20, v63, v63, v20
    v_dot2_f32_bf16 v19, v64, v64, v19
    v_dot2_f32_bf16 v20, v65, v65, v20
    v_dot2_f32_bf16 v19, v66, v66, v19
    v_dot2_f32_bf16 v20, v67, v67, v20
    v_dot2_f32_bf16 v19, v68, v68, v19
    v_dot2_f32_bf16 v20, v69, v69, v20
    v_dot2_f32_bf16 v19, v70, v70, v19
    v_dot2_f32_bf16 v20, v71, v71, v20
    v_dot2_f32_bf16 v19, v72, v72, v19
    v_dot2_f32_bf16 v20, v73, v73, v20
    v_dot2_f32_bf16 v19, v74, v74, v19
    v_dot2_f32_bf16 v20, v75, v75, v20
    v_dot2_f32_bf16 v19, v76, v76, v19
    v_dot2_f32_bf16 v20, v77, v77, v20
    v_dot2_f32_bf16 v19, v78, v78, v19
    v_dot2_f32_bf16 v20, v79, v79, v20
    s_nop 2
    v_add_f32 v19, v19, v20
    s_nop 1
    v_add_f32_dpp v19, v19, v19 quad_perm:[1,0,3,2] row_mask:0xf bank_mask:0xf
    s_nop 1
    v_add_f32_dpp v19, v19, v19 quad_perm:[2,3,0,1] row_mask:0xf bank_mask:0xf
    s_nop 1
    v_add_f32_dpp v19, v19, v19 row_half_mirror row_mask:0xf bank_mask:0xf
    v_mov_b32 v18, 0x3727c5ac
    v_fmac_f32 v18, 0x3acccccd, v19
    v_rsq_f32 v19, v18
    s_nop 0
    ds_write_b32 v14, v19
    ds_add_u32 v13, v140 offset:348
    v_add_u32 v4, s57, v136
    v_add_u32 v5, s57, v137
    s_cmp_lt_u32 s50, 4
    s_cbranch_scc1 A_QP
    buffer_load_dwordx4 v[40:43], v161, s[40:43], s71 offen
    buffer_load_dwordx4 v[44:47], v162, s[40:43], s71 offen
    buffer_load_dwordx4 v[48:51], v163, s[40:43], s71 offen
    buffer_load_dwordx4 v[52:55], v164, s[40:43], s71 offen
    buffer_load_dwordx4 v[56:59], v165, s[40:43], s71 offen
    s_add_u32 s71, s71, 40960
    buffer_load_dwordx4 v[60:63], v161, s[40:43], s71 offen
    buffer_load_dwordx4 v[64:67], v162, s[40:43], s71 offen
    buffer_load_dwordx4 v[68:71], v163, s[40:43], s71 offen
    buffer_load_dwordx4 v[72:75], v164, s[40:43], s71 offen
    buffer_load_dwordx4 v[76:79], v165, s[40:43], s71 offen
    ds_add_u32 v13, v22 offset:344
    v_mov_b32 v88, 0
    v_mov_b32 v89, 0
    v_mov_b32 v90, 0
    v_mov_b32 v91, 0
    v_mov_b32 v92, 0
    v_mov_b32 v93, 0
    v_mov_b32 v94, 0
    v_mov_b32 v95, 0
    v_mov_b32 v96, 0
    v_mov_b32 v97, 0
    v_mov_b32 v98, 0
    v_mov_b32 v99, 0
    v_mov_b32 v100, 0
    v_mov_b32 v101, 0
    v_mov_b32 v102, 0
    v_mov_b32 v103, 0
    s_mov_b32 s63, 1600000
LW_1:
    ds_read_b32 v2, v12 offset:340
    s_waitcnt lgkmcnt(0)
    v_readfirstlane_b32 s52, v2
    s_nop 1
    s_cmp_ge_u32 s52, 1
    s_cbranch_scc1 LWD_2
    s_sleep 1
    s_sub_u32 s63, s63, 1
    s_cmp_lg_u32 s63, 0
    s_cbranch_scc1 LW_1
LWD_2:
    ds_read_b64 v[2:3], v12 offset:256
    s_waitcnt lgkmcnt(0)
    v_readfirstlane_b32 s30, v2
    v_readfirstlane_b32 s31, v3
    s_mov_b32 s63, 1600000
SP_3:
    ds_read_b32 v2, v166 offset:312
    s_waitcnt lgkmcnt(0)
    v_readfirstlane_b32 s52, v2
    s_nop 1
    s_cmp_ge_u32 s52, 4
    s_cbranch_scc1 SPD_4
    s_sleep 1
    s_sub_u32 s63, s63, 1
    s_cmp_lg_u32 s63, 0
    s_cbranch_scc1 SP_3
SPD_4:
    s_waitcnt vmcnt(0)
    ds_write_b128 v141, v[40:43] offset:0
    ds_write_b128 v141, v[44:47] offset:1024
    ds_write_b128 v141, v[48:51] offset:2048
    ds_write_b128 v141, v[52:55] offset:3072
    ds_write_b128 v141, v[56:59] offset:4096
    ds_write_b128 v141, v[60:63] offset:5120
    ds_write_b128 v141, v[64:67] offset:6144
    ds_write_b128 v141, v[68:71] offset:7168
    ds_write_b128 v141, v[72:75] offset:8192
    ds_write_b128 v141, v[76:79] offset:9216
    ds_add_u32 v167, v22 offset:372
    s_cmp_ge_u32 s54, 3
    s_cbranch_scc1 B_NOH
    s_cmp_eq_u32 s54, 0
    s_cselect_b32 s53, 12, 16
    v_add_u32 v166, s53, v12
    s_mov_b32 s63, 1600000
SP_5:
    ds_read_b32 v2, v166 offset:312
    s_waitcnt lgkmcnt(0)
    v_readfirstlane_b32 s52, v2
    s_nop 1
    s_cmp_ge_u32 s52, 4
    s_cbranch_scc1 SPD_6
    s_sleep 1
    s_sub_u32 s63, s63, 1
    s_cmp_lg_u32 s63, 0
    s_cbranch_scc1 SP_5
SPD_6:
    s_mov_b32 s63, 200000
POLL_7:
    buffer_load_dwordx2 v[144:145], v142, s[44:47], s59 offen sc1
    buffer_load_dwordx2 v[146:147], v142, s[44:47], s59 offen offset:128 sc1
    s_waitcnt vmcnt(0)
    v_cmp_ne_u64 vcc, s[30:31], v[144:145]
    v_cmp_ne_u64 s[52:53], s[30:31], v[146:147]
    s_nop 1
    s_or_b64 vcc, vcc, s[52:53]
    s_cmp_eq_u64 vcc, 0
    s_cbranch_scc1 POLLD_8
    s_sleep 4
    s_sub_u32 s63, s63, 1
    s_cmp_lg_u32 s63, 0
    s_cbranch_scc1 POLL_7
POLLD_8:
    s_cmp_eq_u32 s54, 0
    s_cselect_b32 s53, 0, 12
    v_add_u32 v166, s53, v12
    s_mov_b32 s63, 1600000
SP_9:
    ds_read_b32 v2, v166 offset:312
    s_waitcnt lgkmcnt(0)
    v_readfirstlane_b32 s52, v2
    s_nop 1
    s_cmp_ge_u32 s52, 4
    s_cbranch_scc1 SPD_10
    s_sleep 0
    s_sub_u32 s63, s63, 1
    s_cmp_lg_u32 s63, 0
    s_cbranch_scc1 SP_9
SPD_10:
    s_add_u32 m0, s60, 0
    s_add_u32 s52, s58, 0
    buffer_load_dwordx4 v136, s[36:39], s52 offen offset:0 sc1 lds
    buffer_load_dwordx4 v136, s[36:39], s52 offen offset:1024 sc1 lds
    buffer_load_dwordx4 v136, s[36:39], s52 offen offset:2048 sc1 lds
    buffer_load_dwordx4 v136, s[36:39], s52 offen offset:3072 sc1 lds
    s_add_u32 m0, s60, 4096
    s_add_u32 s52, s58, 4096
    buffer_load_dwordx4 v136, s[36:39], s52 offen offset:0 sc1 lds
    buffer_load_dwordx4 v136, s[36:39], s52 offen offset:1024 sc1 lds
    buffer_load_dwordx4 v136, s[36:39], s52 offen offset:2048 sc1 lds
    buffer_load_dwordx4 v136, s[36:39], s52 offen offset:3072 sc1 lds
    s_add_u32 m0, s60, 8192
    s_add_u32 s52, s58, 8192
    buffer_load_dwordx4 v136, s[36:39], s52 offen offset:0 sc1 lds
    buffer_load_dwordx4 v136, s[36:39], s52 offen offset:1024 sc1 lds
    buffer_load_dwordx4 v136, s[36:39], s52 offen offset:2048 sc1 lds
    s_cmp_lg_u32 s54, 2
    s_cbranch_scc1 B_SIG
    s_lshr_b32 s58, s2, 3
    s_mul_i32 s58, s58, 5632
    v_lshlrev_b32 v2, 7, v1
    buffer_load_dword v144, v2, s[36:39], s58 offen sc1
B_SIG:
    v_mov_b32 v2, 1000
    s_cmp_eq_u32 s54, 0
    s_cselect_b32 s52, 4, 0
    v_add_u32 v3, s52, v13
    s_waitcnt vmcnt(0)
    ds_add_u32 v3, v2 offset:272
B_NOH:
    s_mov_b32 s63, 1600000
SP_11:
    ds_read_b32 v2, v113 offset:388
    s_waitcnt lgkmcnt(0)
    v_readfirstlane_b32 s52, v2
    s_nop 1
    s_cmp_ge_u32 s52, 1
    s_cbranch_scc1 SPD_12
    s_sleep 1
    s_sub_u32 s63, s63, 1
    s_cmp_lg_u32 s63, 0
    s_cbranch_scc1 SP_11
SPD_12:
    ds_read_b128 v[148:151], v4
    ds_read_b64 v[112:113], v5 offset:1024
    s_branch A_JOIN
A_QP:
    s_cmp_eq_u32 s15, 0
    s_mov_b32 s52, 4294926336
    s_cmov_b32 s52, 40960
    v_add_u32 v160, s52, v8
    v_add_u32 v161, s52, v9
    v_add_u32 v162, s52, v10
    v_add_u32 v163, s52, v11
    v_xor_b32 v164, 128, v143
    s_mov_b32 s63, 1600000
LW_13:
    ds_read_b32 v2, v12 offset:340
    s_waitcnt lgkmcnt(0)
    v_readfirstlane_b32 s52, v2
    s_nop 1
    s_cmp_ge_u32 s52, 1
    s_cbranch_scc1 LWD_14
    s_sleep 1
    s_sub_u32 s63, s63, 1
    s_cmp_lg_u32 s63, 0
    s_cbranch_scc1 LW_13
LWD_14:
    ds_read_b64 v[2:3], v12 offset:256
    s_waitcnt lgkmcnt(0)
    v_readfirstlane_b32 s30, v2
    v_readfirstlane_b32 s31, v3
    s_mov_b32 s63, 1600000
LW_15:
    ds_read_b32 v23, v12 offset:292
    s_waitcnt lgkmcnt(0)
    v_readfirstlane_b32 s52, v23
    s_nop 1
    s_cmp_ge_u32 s52, 2
    s_cbranch_scc1 LWD_16
    s_sleep 1
    s_sub_u32 s63, s63, 1
    s_cmp_lg_u32 s63, 0
    s_cbranch_scc1 LW_15
LWD_16:
    s_mov_b32 s63, 1600000
LW_17:
    ds_read_b32 v23, v12 offset:336
    s_waitcnt lgkmcnt(0)
    v_readfirstlane_b32 s52, v23
    s_nop 1
    s_cmp_ge_u32 s52, 1028
    s_cbranch_scc1 LWD_18
    s_sleep 1
    s_sub_u32 s63, s63, 1
    s_cmp_lg_u32 s63, 0
    s_cbranch_scc1 LW_17
LWD_18:
    s_setprio 2
    ds_read_b64_tr_b16 v[48:49], v15 offset:0
    ds_read_b64_tr_b16 v[50:51], v15 offset:160
    ds_read_b128 v[44:47], v160 offset:0
    ds_read_b128 v[40:43], v8 offset:0
    ds_read_b64_tr_b16 v[60:61], v15 offset:2560
    ds_read_b64_tr_b16 v[62:63], v15 offset:2720
    ds_read_b128 v[56:59], v161 offset:1024
    ds_read_b128 v[52:55], v9 offset:1024
    ds_read_b64_tr_b16 v[72:73], v15 offset:5120
    ds_read_b64_tr_b16 v[74:75], v15 offset:5280
    ds_read_b128 v[68:71], v162 offset:2048
    ds_read_b128 v[64:67], v10 offset:2048
    s_waitcnt lgkmcnt(8)
    v_mfma_f32_32x32x16_bf16 v[88:103], v[48:51], v[44:47], 0
    ds_read_b64_tr_b16 v[84:85], v15 offset:7680
    ds_read_b64_tr_b16 v[86:87], v15 offset:7840
    ds_read_b128 v[80:83], v163 offset:3072
    ds_read_b128 v[76:79], v11 offset:3072
    v_mfma_f32_32x32x16_bf16 v[24:39], v[48:51], v[40:43], 0
    s_waitcnt lgkmcnt(8)
    v_mfma_f32_32x32x16_bf16 v[88:103], v[60:63], v[56:59], v[88:103]
    ds_read_b64_tr_b16 v[48:49], v15 offset:11264
    ds_read_b64_tr_b16 v[50:51], v15 offset:11424
    ds_read_b128 v[44:47], v160 offset:4096
    ds_read_b128 v[40:43], v8 offset:4096
    v_mfma_f32_32x32x16_bf16 v[24:39], v[60:63], v[52:55], v[24:39]
    s_waitcnt lgkmcnt(8)
    v_mfma_f32_32x32x16_bf16 v[88:103], v[72:75], v[68:71], v[88:103]
    ds_read_b64_tr_b16 v[60:61], v15 offset:13824
    ds_read_b64_tr_b16 v[62:63], v15 offset:13984
    ds_read_b128 v[56:59], v161 offset:5120
    ds_read_b128 v[52:55], v9 offset:5120
    v_mfma_f32_32x32x16_bf16 v[24:39], v[72:75], v[64:67], v[24:39]
    s_waitcnt lgkmcnt(8)
    v_mfma_f32_32x32x16_bf16 v[88:103], v[84:87], v[80:83], v[88:103]
    ds_read_b64_tr_b16 v[72:73], v15 offset:16384
    ds_read_b64_tr_b16 v[74:75], v15 offset:16544
    ds_read_b128 v[68:71], v162 offset:6144
    ds_read_b128 v[64:67], v10 offset:6144
    ds_read_b32 v23, v12 offset:296
    v_mfma_f32_32x32x16_bf16 v[24:39], v[84:87], v[76:79], v[24:39]
    s_waitcnt lgkmcnt(9)
    v_mfma_f32_32x32x16_bf16 v[88:103], v[48:51], v[44:47], v[88:103]
    ds_read_b64_tr_b16 v[84:85], v15 offset:18944
    ds_read_b64_tr_b16 v[86:87], v15 offset:19104
    ds_read_b128 v[80:83], v163 offset:7168
    ds_read_b128 v[76:79], v11 offset:7168
    ds_add_u32 v13, v22 offset:312
    v_mfma_f32_32x32x16_bf16 v[24:39], v[48:51], v[40:43], v[24:39]
    s_waitcnt lgkmcnt(10)
    v_mfma_f32_32x32x16_bf16 v[88:103], v[60:63], v[56:59], v[88:103]
    s_waitcnt lgkmcnt(5)
    v_readfirstlane_b32 s52, v23
    s_nop 1
    s_cmp_ge_u32 s52, 2
    s_cbranch_scc1 QOK_19
    s_mov_b32 s63, 1600000
LW_20:
    ds_read_b32 v23, v12 offset:296
    s_waitcnt lgkmcnt(0)
    v_readfirstlane_b32 s52, v23
    s_nop 1
    s_cmp_ge_u32 s52, 2
    s_cbranch_scc1 LWD_21
    s_sleep 1
    s_sub_u32 s63, s63, 1
    s_cmp_lg_u32 s63, 0
    s_cbranch_scc1 LW_20
LWD_21:
QOK_19:
    ds_read_b64_tr_b16 v[48:49], v15 offset:22528
    ds_read_b64_tr_b16 v[50:51], v15 offset:22688
    ds_read_b128 v[44:47], v160 offset:8192
    ds_read_b128 v[40:43], v8 offset:8192
    v_mfma_f32_32x32x16_bf16 v[24:39], v[60:63], v[52:55], v[24:39]
    s_waitcnt lgkmcnt(10)
    v_mfma_f32_32x32x16_bf16 v[88:103], v[72:75], v[68:71], v[88:103]
    ds_read_b64_tr_b16 v[60:61], v15 offset:25088
    ds_read_b64_tr_b16 v[62:63], v15 offset:25248
    ds_read_b128 v[56:59], v161 offset:9216
    ds_read_b128 v[52:55], v9 offset:9216
    v_mfma_f32_32x32x16_bf16 v[24:39], v[72:75], v[64:67], v[24:39]
    s_waitcnt lgkmcnt(9)
    v_mfma_f32_32x32x16_bf16 v[88:103], v[84:87], v[80:83], v[88:103]
    ds_read_b64_tr_b16 v[72:73], v15 offset:27648
    ds_read_b64_tr_b16 v[74:75], v15 offset:27808
    ds_read_b128 v[68:71], v162 offset:10240
    ds_read_b128 v[64:67], v10 offset:10240
    v_mfma_f32_32x32x16_bf16 v[24:39], v[84:87], v[76:79], v[24:39]
    s_waitcnt lgkmcnt(8)
    v_mfma_f32_32x32x16_bf16 v[88:103], v[48:51], v[44:47], v[88:103]
    ds_read_b64_tr_b16 v[84:85], v15 offset:30208
    ds_read_b64_tr_b16 v[86:87], v15 offset:30368
    ds_read_b128 v[80:83], v163 offset:11264
    ds_read_b128 v[76:79], v11 offset:11264
    v_mfma_f32_32x32x16_bf16 v[24:39], v[48:51], v[40:43], v[24:39]
    s_waitcnt lgkmcnt(8)
    v_mfma_f32_32x32x16_bf16 v[88:103], v[60:63], v[56:59], v[88:103]
    ds_read_b64_tr_b16 v[48:49], v15 offset:33792
    ds_read_b64_tr_b16 v[50:51], v15 offset:33952
    ds_read_b128 v[44:47], v160 offset:12288
    ds_read_b128 v[40:43], v8 offset:12288
    v_mfma_f32_32x32x16_bf16 v[24:39], v[60:63], v[52:55], v[24:39]
    s_waitcnt lgkmcnt(8)
    v_mfma_f32_32x32x16_bf16 v[88:103], v[72:75], v[68:71], v[88:103]
    ds_read_b64_tr_b16 v[60:61], v15 offset:36352
    ds_read_b64_tr_b16 v[62:63], v15 offset:36512
    ds_read_b128 v[56:59], v161 offset:13312
    ds_read_b128 v[52:55], v9 offset:13312
    v_mfma_f32_32x32x16_bf16 v[24:39], v[72:75], v[64:67], v[24:39]
    s_waitcnt lgkmcnt(8)
    v_mfma_f32_32x32x16_bf16 v[88:103], v[84:87], v[80:83], v[88:103]
    ds_read_b64_tr_b16 v[72:73], v15 offset:38912
    ds_read_b64_tr_b16 v[74:75], v15 offset:39072
    ds_read_b128 v[68:71], v162 offset:14336
    ds_read_b128 v[64:67], v10 offset:14336
    ds_read_b32 v23, v12 offset:300
    v_mfma_f32_32x32x16_bf16 v[24:39], v[84:87], v[76:79], v[24:39]
    s_waitcnt lgkmcnt(9)
    v_mfma_f32_32x32x16_bf16 v[88:103], v[48:51], v[44:47], v[88:103]
    ds_read_b64_tr_b16 v[84:85], v15 offset:41472
    ds_read_b64_tr_b16 v[86:87], v15 offset:41632
    ds_read_b128 v[80:83], v163 offset:15360
    ds_read_b128 v[76:79], v11 offset:15360
    ds_add_u32 v13, v22 offset:316
    v_mfma_f32_32x32x16_bf16 v[24:39], v[48:51], v[40:43], v[24:39]
    s_waitcnt lgkmcnt(10)
    v_mfma_f32_32x32x16_bf16 v[88:103], v[60:63], v[56:59], v[88:103]
    s_waitcnt lgkmcnt(5)
    v_readfirstlane_b32 s52, v23
    s_nop 1
    s_cmp_ge_u32 s52, 2
    s_cbranch_scc1 QOK_22
    s_mov_b32 s63, 1600000
LW_23:
    ds_read_b32 v23, v12 offset:300
    s_waitcnt lgkmcnt(0)
    v_readfirstlane_b32 s52, v23
    s_nop 1
    s_cmp_ge_u32 s52, 2
    s_cbranch_scc1 LWD_24
    s_sleep 1
    s_sub_u32 s63, s63, 1
    s_cmp_lg_u32 s63, 0
    s_cbranch_scc1 LW_23
LWD_24:
QOK_22:
    ds_read_b64_tr_b16 v[48:49], v16 offset:0
    ds_read_b64_tr_b16 v[50:51], v16 offset:160
    ds_read_b128 v[44:47], v160 offset:16384
    ds_read_b128 v[40:43], v8 offset:16384
    v_mfma_f32_32x32x16_bf16 v[24:39], v[60:63], v[52:55], v[24:39]
    s_waitcnt lgkmcnt(10)
    v_mfma_f32_32x32x16_bf16 v[88:103], v[72:75], v[68:71], v[88:103]
    ds_read_b64_tr_b16 v[60:61], v16 offset:2560
    ds_read_b64_tr_b16 v[62:63], v16 offset:2720
    ds_read_b128 v[56:59], v161 offset:17408
    ds_read_b128 v[52:55], v9 offset:17408
    v_mfma_f32_32x32x16_bf16 v[24:39], v[72:75], v[64:67], v[24:39]
    s_waitcnt lgkmcnt(9)
    v_mfma_f32_32x32x16_bf16 v[88:103], v[84:87], v[80:83], v[88:103]
    ds_read_b64_tr_b16 v[72:73], v16 offset:5120
    ds_read_b64_tr_b16 v[74:75], v16 offset:5280
    ds_read_b128 v[68:71], v162 offset:18432
    ds_read_b128 v[64:67], v10 offset:18432
    ds_read_b32 v23, v12 offset:348
    v_mfma_f32_32x32x16_bf16 v[24:39], v[84:87], v[76:79], v[24:39]
    s_waitcnt lgkmcnt(9)
    v_mfma_f32_32x32x16_bf16 v[88:103], v[48:51], v[44:47], v[88:103]
    ds_read_b64_tr_b16 v[84:85], v16 offset:7680
    ds_read_b64_tr_b16 v[86:87], v16 offset:7840
    ds_read_b128 v[80:83], v163 offset:19456
    ds_read_b128 v[76:79], v11 offset:19456
    v_mfma_f32_32x32x16_bf16 v[24:39], v[48:51], v[40:43], v[24:39]
    s_waitcnt lgkmcnt(9)
    v_mfma_f32_32x32x16_bf16 v[88:103], v[60:63], v[56:59], v[88:103]
    s_waitcnt lgkmcnt(4)
    v_readfirstlane_b32 s52, v23
    s_nop 1
    s_cmp_ge_u32 s52, 1028
    s_cbranch_scc1 QOK_25
    s_mov_b32 s63, 1600000
LW_26:
    ds_read_b32 v23, v12 offset:348
    s_waitcnt lgkmcnt(0)
    v_readfirstlane_b32 s52, v23
    s_nop 1
    s_cmp_ge_u32 s52, 1028
    s_cbranch_scc1 LWD_27
    s_sleep 1
    s_sub_u32 s63, s63, 1
    s_cmp_lg_u32 s63, 0
    s_cbranch_scc1 LW_26
LWD_27:
QOK_25:
    ds_read_b32 v143, v143
    ds_read_b32 v164, v164
    ds_read_b64_tr_b16 v[48:49], v16 offset:10240
    ds_read_b64_tr_b16 v[50:51], v16 offset:10400
    ds_read_b128 v[44:47], v160 offset:20480
    ds_read_b128 v[40:43], v8 offset:20480
    v_mfma_f32_32x32x16_bf16 v[24:39], v[60:63], v[52:55], v[24:39]
    s_waitcnt lgkmcnt(11)
    v_mfma_f32_32x32x16_bf16 v[88:103], v[72:75], v[68:71], v[88:103]
    ds_read_b64_tr_b16 v[60:61], v16 offset:12800
    ds_read_b64_tr_b16 v[62:63], v16 offset:12960
    ds_read_b128 v[56:59], v161 offset:21504
    ds_read_b128 v[52:55], v9 offset:21504
    v_mfma_f32_32x32x16_bf16 v[24:39], v[72:75], v[64:67], v[24:39]
    s_waitcnt lgkmcnt(10)
    v_mfma_f32_32x32x16_bf16 v[88:103], v[84:87], v[80:83], v[88:103]
    ds_read_b64_tr_b16 v[72:73], v16 offset:15360
    ds_read_b64_tr_b16 v[74:75], v16 offset:15520
    ds_read_b128 v[68:71], v162 offset:22528
    ds_read_b128 v[64:67], v10 offset:22528
    ds_read_b32 v23, v12 offset:372
    v_mfma_f32_32x32x16_bf16 v[24:39], v[84:87], v[76:79], v[24:39]
    s_waitcnt lgkmcnt(9)
    v_mfma_f32_32x32x16_bf16 v[88:103], v[48:51], v[44:47], v[88:103]
    ds_read_b64_tr_b16 v[84:85], v16 offset:17920
    ds_read_b64_tr_b16 v[86:87], v16 offset:18080
    ds_read_b128 v[80:83], v163 offset:23552
    ds_read_b128 v[76:79], v11 offset:23552
    ds_add_u32 v13, v22 offset:320
    v_mfma_f32_32x32x16_bf16 v[24:39], v[48:51], v[40:43], v[24:39]
    s_waitcnt lgkmcnt(10)
    v_mfma_f32_32x32x16_bf16 v[88:103], v[60:63], v[56:59], v[88:103]
    s_waitcnt lgkmcnt(5)
    v_readfirstlane_b32 s52, v23
    s_nop 1
    s_cmp_ge_u32 s52, 1
    s_cbranch_scc1 QOK_28
    s_mov_b32 s63, 1600000
LW_29:
    ds_read_b32 v23, v12 offset:372
    s_waitcnt lgkmcnt(0)
    v_readfirstlane_b32 s52, v23
    s_nop 1
    s_cmp_ge_u32 s52, 1
    s_cbranch_scc1 LWD_30
    s_sleep 1
    s_sub_u32 s63, s63, 1
    s_cmp_lg_u32 s63, 0
    s_cbranch_scc1 LW_29
LWD_30:
QOK_28:
    ds_read_b64_tr_b16 v[48:49], v15 offset:11264
    ds_read_b64_tr_b16 v[50:51], v15 offset:11424
    ds_read_b128 v[44:47], v160 offset:24576
    ds_read_b128 v[40:43], v8 offset:24576
    v_mfma_f32_32x32x16_bf16 v[24:39], v[60:63], v[52:55], v[24:39]
    s_waitcnt lgkmcnt(10)
    v_mfma_f32_32x32x16_bf16 v[88:103], v[72:75], v[68:71], v[88:103]
    ds_read_b64_tr_b16 v[60:61], v15 offset:13824
    ds_read_b64_tr_b16 v[62:63], v15 offset:13984
    ds_read_b128 v[56:59], v161 offset:25600
    ds_read_b128 v[52:55], v9 offset:25600
    v_mfma_f32_32x32x16_bf16 v[24:39], v[72:75], v[64:67], v[24:39]
    s_waitcnt lgkmcnt(9)
    v_mfma_f32_32x32x16_bf16 v[88:103], v[84:87], v[80:83], v[88:103]
    ds_read_b64_tr_b16 v[72:73], v15 offset:16384
    ds_read_b64_tr_b16 v[74:75], v15 offset:16544
    ds_read_b128 v[68:71], v162 offset:26624
    ds_read_b128 v[64:67], v10 offset:26624
    ds_read_b32 v23, v12 offset:376
    v_mfma_f32_32x32x16_bf16 v[24:39], v[84:87], v[76:79], v[24:39]
    s_waitcnt lgkmcnt(9)
    v_mfma_f32_32x32x16_bf16 v[88:103], v[48:51], v[44:47], v[88:103]
    ds_read_b64_tr_b16 v[84:85], v15 offset:18944
    ds_read_b64_tr_b16 v[86:87], v15 offset:19104
    ds_read_b128 v[80:83], v163 offset:27648
    ds_read_b128 v[76:79], v11 offset:27648
    v_mfma_f32_32x32x16_bf16 v[24:39], v[48:51], v[40:43], v[24:39]
    s_waitcnt lgkmcnt(9)
    v_mfma_f32_32x32x16_bf16 v[88:103], v[60:63], v[56:59], v[88:103]
    s_waitcnt lgkmcnt(4)
    v_readfirstlane_b32 s52, v23
    s_nop 1
    s_cmp_ge_u32 s52, 1
    s_cbranch_scc1 QOK_31
    s_mov_b32 s63, 1600000
LW_32:
    ds_read_b32 v23, v12 offset:376
    s_waitcnt lgkmcnt(0)
    v_readfirstlane_b32 s52, v23
    s_nop 1
    s_cmp_ge_u32 s52, 1
    s_cbranch_scc1 LWD_33
    s_sleep 1
    s_sub_u32 s63, s63, 1
    s_cmp_lg_u32 s63, 0
    s_cbranch_scc1 LW_32
LWD_33:
QOK_31:
    ds_read_b64_tr_b16 v[48:49], v15 offset:22528
    ds_read_b64_tr_b16 v[50:51], v15 offset:22688
    ds_read_b128 v[44:47], v160 offset:28672
    ds_read_b128 v[40:43], v8 offset:28672
    v_mfma_f32_32x32x16_bf16 v[24:39], v[60:63], v[52:55], v[24:39]
    s_waitcnt lgkmcnt(9)
    v_mfma_f32_32x32x16_bf16 v[88:103], v[72:75], v[68:71], v[88:103]
    ds_read_b64_tr_b16 v[60:61], v15 offset:25088
    ds_read_b64_tr_b16 v[62:63], v15 offset:25248
    ds_read_b128 v[56:59], v161 offset:29696
    ds_read_b128 v[52:55], v9 offset:29696
    v_mfma_f32_32x32x16_bf16 v[24:39], v[72:75], v[64:67], v[24:39]
    s_waitcnt lgkmcnt(8)
    v_mfma_f32_32x32x16_bf16 v[88:103], v[84:87], v[80:83], v[88:103]
    ds_read_b64_tr_b16 v[72:73], v15 offset:27648
    ds_read_b64_tr_b16 v[74:75], v15 offset:27808
    ds_read_b128 v[68:71], v162 offset:30720
    ds_read_b128 v[64:67], v10 offset:30720
    ds_read_b32 v23, v12 offset:380
    v_mfma_f32_32x32x16_bf16 v[24:39], v[84:87], v[76:79], v[24:39]
    s_waitcnt lgkmcnt(9)
    v_mfma_f32_32x32x16_bf16 v[88:103], v[48:51], v[44:47], v[88:103]
    ds_read_b64_tr_b16 v[84:85], v15 offset:30208
    ds_read_b64_tr_b16 v[86:87], v15 offset:30368
    ds_read_b128 v[80:83], v163 offset:31744
    ds_read_b128 v[76:79], v11 offset:31744
    ds_add_u32 v13, v22 offset:324
    v_mfma_f32_32x32x16_bf16 v[24:39], v[48:51], v[40:43], v[24:39]
    s_waitcnt lgkmcnt(10)
    v_mfma_f32_32x32x16_bf16 v[88:103], v[60:63], v[56:59], v[88:103]
    s_waitcnt lgkmcnt(5)
    v_readfirstlane_b32 s52, v23
    s_nop 1
    s_cmp_ge_u32 s52, 1
    s_cbranch_scc1 QOK_34
    s_mov_b32 s63, 1600000
LW_35:
    ds_read_b32 v23, v12 offset:380
    s_waitcnt lgkmcnt(0)
    v_readfirstlane_b32 s52, v23
    s_nop 1
    s_cmp_ge_u32 s52, 1
    s_cbranch_scc1 LWD_36
    s_sleep 1
    s_sub_u32 s63, s63, 1
    s_cmp_lg_u32 s63, 0
    s_cbranch_scc1 LW_35
LWD_36:
QOK_34:
    ds_read_b64_tr_b16 v[48:49], v15 offset:33792
    ds_read_b64_tr_b16 v[50:51], v15 offset:33952
    ds_read_b128 v[44:47], v160 offset:32768
    ds_read_b128 v[40:43], v8 offset:32768
    v_mfma_f32_32x32x16_bf16 v[24:39], v[60:63], v[52:55], v[24:39]
    s_waitcnt lgkmcnt(10)
    v_mfma_f32_32x32x16_bf16 v[88:103], v[72:75], v[68:71], v[88:103]
    ds_read_b64_tr_b16 v[60:61], v15 offset:36352
    ds_read_b64_tr_b16 v[62:63], v15 offset:36512
    ds_read_b128 v[56:59], v161 offset:33792
    ds_read_b128 v[52:55], v9 offset:33792
    v_mfma_f32_32x32x16_bf16 v[24:39], v[72:75], v[64:67], v[24:39]
    s_waitcnt lgkmcnt(9)
    v_mfma_f32_32x32x16_bf16 v[88:103], v[84:87], v[80:83], v[88:103]
    ds_read_b64_tr_b16 v[72:73], v15 offset:38912
    ds_read_b64_tr_b16 v[74:75], v15 offset:39072
    ds_read_b128 v[68:71], v162 offset:34816
    ds_read_b128 v[64:67], v10 offset:34816
    ds_read_b32 v23, v12 offset:384
    v_mfma_f32_32x32x16_bf16 v[24:39], v[84:87], v[76:79], v[24:39]
    s_waitcnt lgkmcnt(9)
    v_mfma_f32_32x32x16_bf16 v[88:103], v[48:51], v[44:47], v[88:103]
    ds_read_b64_tr_b16 v[84:85], v15 offset:41472
    ds_read_b64_tr_b16 v[86:87], v15 offset:41632
    ds_read_b128 v[80:83], v163 offset:35840
    ds_read_b128 v[76:79], v11 offset:35840
    v_mfma_f32_32x32x16_bf16 v[24:39], v[48:51], v[40:43], v[24:39]
    s_waitcnt lgkmcnt(9)
    v_mfma_f32_32x32x16_bf16 v[88:103], v[60:63], v[56:59], v[88:103]
    s_waitcnt lgkmcnt(4)
    v_readfirstlane_b32 s52, v23
    s_nop 1
    s_cmp_ge_u32 s52, 1
    s_cbranch_scc1 QOK_37
    s_mov_b32 s63, 1600000
LW_38:
    ds_read_b32 v23, v12 offset:384
    s_waitcnt lgkmcnt(0)
    v_readfirstlane_b32 s52, v23
    s_nop 1
    s_cmp_ge_u32 s52, 1
    s_cbranch_scc1 LWD_39
    s_sleep 1
    s_sub_u32 s63, s63, 1
    s_cmp_lg_u32 s63, 0
    s_cbranch_scc1 LW_38
LWD_39:
QOK_37:
    ds_read_b64_tr_b16 v[48:49], v16 offset:0
    ds_read_b64_tr_b16 v[50:51], v16 offset:160
    ds_read_b128 v[44:47], v160 offset:36864
    ds_read_b128 v[40:43], v8 offset:36864
    v_mfma_f32_32x32x16_bf16 v[24:39], v[60:63], v[52:55], v[24:39]
    s_waitcnt lgkmcnt(9)
    v_mfma_f32_32x32x16_bf16 v[88:103], v[72:75], v[68:71], v[88:103]
    ds_read_b64_tr_b16 v[60:61], v16 offset:2560
    ds_read_b64_tr_b16 v[62:63], v16 offset:2720
    ds_read_b128 v[56:59], v161 offset:37888
    ds_read_b128 v[52:55], v9 offset:37888
    v_mfma_f32_32x32x16_bf16 v[24:39], v[72:75], v[64:67], v[24:39]
    s_waitcnt lgkmcnt(8)
    v_mfma_f32_32x32x16_bf16 v[88:103], v[84:87], v[80:83], v[88:103]
    ds_read_b64_tr_b16 v[72:73], v16 offset:5120
    ds_read_b64_tr_b16 v[74:75], v16 offset:5280
    ds_read_b128 v[68:71], v162 offset:38912
    ds_read_b128 v[64:67], v10 offset:38912
    ds_read_b32 v23, v12 offset:320
    v_mfma_f32_32x32x16_bf16 v[24:39], v[84:87], v[76:79], v[24:39]
    s_waitcnt lgkmcnt(9)
    v_mfma_f32_32x32x16_bf16 v[88:103], v[48:51], v[44:47], v[88:103]
    ds_read_b64_tr_b16 v[84:85], v16 offset:7680
    ds_read_b64_tr_b16 v[86:87], v16 offset:7840
    ds_read_b128 v[80:83], v163 offset:39936
    ds_read_b128 v[76:79], v11 offset:39936
    ds_add_u32 v13, v22 offset:328
    v_mfma_f32_32x32x16_bf16 v[24:39], v[48:51], v[40:43], v[24:39]
    s_waitcnt lgkmcnt(10)
    v_mfma_f32_32x32x16_bf16 v[88:103], v[60:63], v[56:59], v[88:103]
    v_mfma_f32_32x32x16_bf16 v[24:39], v[60:63], v[52:55], v[24:39]
    s_waitcnt lgkmcnt(6)
    v_mfma_f32_32x32x16_bf16 v[88:103], v[72:75], v[68:71], v[88:103]
    v_mfma_f32_32x32x16_bf16 v[24:39], v[72:75], v[64:67], v[24:39]
    s_waitcnt lgkmcnt(1)
    v_mfma_f32_32x32x16_bf16 v[88:103], v[84:87], v[80:83], v[88:103]
    v_mfma_f32_32x32x16_bf16 v[24:39], v[84:87], v[76:79], v[24:39]
    s_waitcnt lgkmcnt(5)
    v_readfirstlane_b32 s52, v23
    s_nop 1
    s_cmp_ge_u32 s52, 4
    s_cbranch_scc1 QOK_40
    s_mov_b32 s63, 1600000
LW_41:
    ds_read_b32 v23, v12 offset:320
    s_waitcnt lgkmcnt(0)
    v_readfirstlane_b32 s52, v23
    s_nop 1
    s_cmp_ge_u32 s52, 4
    s_cbranch_scc1 LWD_42
    s_sleep 1
    s_sub_u32 s63, s63, 1
    s_cmp_lg_u32 s63, 0
    s_cbranch_scc1 LW_41
LWD_42:
QOK_40:
    v_mul_f32 v143, 0x3ea52b5c, v143
    v_mul_f32 v164, 0x3ea52b5c, v164
    s_nop 3
    v_mul_f32 v88, v164, v88
    v_mul_f32 v89, v164, v89
    v_mul_f32 v90, v164, v90
    v_mul_f32 v91, v164, v91
    v_mul_f32 v92, v164, v92
    v_mul_f32 v93, v164, v93
    v_mul_f32 v94, v164, v94
    v_mul_f32 v95, v164, v95
    v_mul_f32 v96, v164, v96
    v_mul_f32 v97, v164, v97
    v_mul_f32 v98, v164, v98
    v_mul_f32 v99, v164, v99
    v_cvt_pk_bf16_f32 v40, v88, v89
    v_cvt_pk_bf16_f32 v41, v90, v91
    v_cvt_pk_bf16_f32 v42, v92, v93
    v_cvt_pk_bf16_f32 v43, v94, v95
    v_cvt_pk_bf16_f32 v44, v96, v97
    v_cvt_pk_bf16_f32 v45, v98, v99
    ds_write_b128 v4, v[40:43]
    ds_write_b64 v5, v[44:45] offset:1024
    ds_add_u32 v167, v22 offset:388
    v_mul_f32 v24, v143, v24
    v_mul_f32 v25, v143, v25
    v_mul_f32 v26, v143, v26
    v_mul_f32 v27, v143, v27
    v_mul_f32 v28, v143, v28
    v_mul_f32 v29, v143, v29
    v_mul_f32 v30, v143, v30
    v_mul_f32 v31, v143, v31
    v_mul_f32 v32, v143, v32
    v_mul_f32 v33, v143, v33
    v_mul_f32 v34, v143, v34
    v_mul_f32 v35, v143, v35
    v_cvt_pk_bf16_f32 v148, v24, v25
    v_cvt_pk_bf16_f32 v149, v26, v27
    v_cvt_pk_bf16_f32 v150, v28, v29
    v_cvt_pk_bf16_f32 v151, v30, v31
    v_cvt_pk_bf16_f32 v112, v32, v33
    v_cvt_pk_bf16_f32 v113, v34, v35
    v_mov_b32 v88, 0
    v_mov_b32 v89, 0
    v_mov_b32 v90, 0
    v_mov_b32 v91, 0
    v_mov_b32 v92, 0
    v_mov_b32 v93, 0
    v_mov_b32 v94, 0
    v_mov_b32 v95, 0
    v_mov_b32 v96, 0
    v_mov_b32 v97, 0
    v_mov_b32 v98, 0
    v_mov_b32 v99, 0
    v_mov_b32 v100, 0
    v_mov_b32 v101, 0
    v_mov_b32 v102, 0
    v_mov_b32 v103, 0
A_JOIN:
    ds_read_b32 v23, v12 offset:276
    s_lshl_b32 s54, s50, 10
    s_add_u32 s55, s54, 8192
    s_cmp_lt_u32 s50, 3
    s_cselect_b32 s55, s55, 163840
    s_cselect_b32 s61, 8192, 1073741824
    s_add_u32 s56, s14, 3
    s_mov_b32 s57, 3
    s_mov_b32 s58, 2008
    v_cmp_eq_u32 vcc, 0, v7
    s_waitcnt lgkmcnt(0)
    v_readfirstlane_b32 s52, v23
    s_nop 1
    s_cmp_lg_u32 s52, 0
    s_cbranch_scc1 A_KVOK
    s_mov_b32 s63, 1600000
LW_43:
    ds_read_b32 v23, v12 offset:276
    s_waitcnt lgkmcnt(0)
    v_readfirstlane_b32 s52, v23
    s_nop 1
    s_cmp_ge_u32 s52, 1
    s_cbranch_scc1 LWD_44
    s_sleep 1
    s_sub_u32 s63, s63, 1
    s_cmp_lg_u32 s63, 0
    s_cbranch_scc1 LW_43
LWD_44:
A_KVOK:
    ds_read_b128 v[128:131], v136 offset:0
    ds_read_b64 v[124:125], v137 offset:4096
    ds_read_b128 v[120:123], v136 offset:1024
    s_waitcnt lgkmcnt(0)
    v_mfma_f32_32x32x16_bf16 v[40:55], v[128:131], v[148:151], 0
    v_cndmask_b32 v152, 0, v112, vcc
    v_cndmask_b32 v156, v112, 0, vcc
    v_cndmask_b32 v153, 0, v113, vcc
    v_cndmask_b32 v157, v113, 0, vcc
    v_mfma_f32_32x32x16_bf16 v[56:71], v[120:123], v[148:151], 0
    s_nop 0
    v_mfma_f32_32x32x16_bf16 v[40:55], v[124:127], v[152:155], v[40:55]
    v_mfma_f32_32x32x16_bf16 v[56:71], v[124:127], v[156:159], v[56:71]
    s_nop 10
    v_max_f32 v140, v40, v41
    v_max3_f32 v140, v42, v43, v140
    v_max3_f32 v140, v44, v45, v140
    v_max3_f32 v140, v46, v47, v140
    v_max3_f32 v140, v48, v49, v140
    v_max3_f32 v140, v50, v51, v140
    v_max3_f32 v140, v52, v53, v140
    v_max3_f32 v140, v54, v55, v140
    v_mfma_f32_32x32x16_bf16 v[40:55], v[128:131], v[148:151], 0
    v_max3_f32 v140, v56, v57, v140
    v_max3_f32 v140, v58, v59, v140
    v_max3_f32 v140, v60, v61, v140
    v_max3_f32 v140, v62, v63, v140
    v_max3_f32 v140, v64, v65, v140
    v_max3_f32 v140, v66, v67, v140
    v_max3_f32 v140, v68, v69, v140
    v_max3_f32 v140, v70, v71, v140
    v_mov_b32 v2, v140
    s_nop 1
    v_permlane32_swap_b32 v2, v140
    s_nop 0
    v_max_f32 v140, v140, v2
    v_sub_f32 v140, 0xc2c80000, v140
    v_cvt_pk_bf16_f32 v140, v140, 0
    v_cndmask_b32 v154, 0, v140, vcc
    v_cndmask_b32 v158, v140, 0, vcc
    s_nop 0
    v_mfma_f32_32x32x16_bf16 v[40:55], v[124:127], v[152:155], v[40:55]
    s_nop 6
    s_setprio 2
.p2align 6
A_LOOP:
    s_setprio 1
    s_waitcnt lgkmcnt(1)
    v_mfma_f32_32x32x16_bf16 v[56:71], v[120:123], v[148:151], 0
    ds_read_b128 v[128:131], v138 offset:5120
    v_cvt_pk_bf16_f32 v110, v116, v117
    v_cvt_pk_bf16_f32 v111, v118, v119
    v_exp_f32 v112, v40
    v_exp_f32 v113, v41
    v_exp_f32 v114, v42
    v_exp_f32 v115, v43
    s_waitcnt lgkmcnt(1)
    v_mfma_f32_32x32x16_bf16 v[88:103], v[132:135], v[108:111], v[88:103]
    ds_read_b128 v[120:123], v136 offset:2048
    s_waitcnt vmcnt(2)
    ds_add_u32 v13, v22 offset:272
    v_cvt_pk_bf16_f32 v104, v112, v113
    v_cvt_pk_bf16_f32 v105, v114, v115
    v_exp_f32 v116, v44
    v_exp_f32 v117, v45
    v_exp_f32 v118, v46
    v_exp_f32 v119, v47
    v_mfma_f32_32x32x16_bf16 v[56:71], v[124:127], v[156:159], v[56:71]
    ds_read_b128 v[132:135], v138 offset:5888
    v_cvt_pk_bf16_f32 v106, v116, v117
    v_cvt_pk_bf16_f32 v107, v118, v119
    v_exp_f32 v112, v48
    v_exp_f32 v113, v49
    v_exp_f32 v114, v50
    v_exp_f32 v115, v51
    s_waitcnt lgkmcnt(3)
    v_mfma_f32_32x32x16_bf16 v[88:103], v[128:131], v[104:107], v[88:103]
    ds_read_b64 v[124:125], v137 offset:4608
    v_cvt_pk_bf16_f32 v108, v112, v113
    v_cvt_pk_bf16_f32 v109, v114, v115
    v_exp_f32 v116, v52
    v_exp_f32 v117, v53
    v_exp_f32 v118, v54
    v_exp_f32 v119, v55
    s_setprio 0
    s_waitcnt lgkmcnt(3)
    v_mfma_f32_32x32x16_bf16 v[40:55], v[120:123], v[148:151], 0
    ds_read_b128 v[128:131], v138 offset:6656
    v_cvt_pk_bf16_f32 v110, v116, v117
    v_cvt_pk_bf16_f32 v111, v118, v119
    v_exp_f32 v112, v56
    v_exp_f32 v113, v57
    v_exp_f32 v114, v58
    v_exp_f32 v115, v59
    s_waitcnt lgkmcnt(2)
    v_mfma_f32_32x32x16_bf16 v[88:103], v[132:135], v[108:111], v[88:103]
    ds_read_b128 v[120:123], v136 offset:3072
    v_cvt_pk_bf16_f32 v104, v112, v113
    v_cvt_pk_bf16_f32 v105, v114, v115
    v_exp_f32 v116, v60
    v_exp_f32 v117, v61
    v_exp_f32 v118, v62
    v_exp_f32 v119, v63
    s_waitcnt lgkmcnt(2)
    v_mfma_f32_32x32x16_bf16 v[40:55], v[124:127], v[152:155], v[40:55]
    ds_read_b128 v[132:135], v138 offset:7424
    v_cvt_pk_bf16_f32 v106, v116, v117
    v_cvt_pk_bf16_f32 v107, v118, v119
    v_exp_f32 v112, v64
    v_exp_f32 v113, v65
    v_exp_f32 v114, v66
    v_exp_f32 v115, v67
    s_waitcnt lgkmcnt(2)
    v_mfma_f32_32x32x16_bf16 v[88:103], v[128:131], v[104:107], v[88:103]
    ds_read_b32 v23, v12 offset:272
    v_cvt_pk_bf16_f32 v108, v112, v113
    v_cvt_pk_bf16_f32 v109, v114, v115
    v_exp_f32 v116, v68
    v_exp_f32 v117, v69
    v_exp_f32 v118, v70
    v_exp_f32 v119, v71
    s_setprio 3
    s_waitcnt lgkmcnt(0)
    v_readfirstlane_b32 s52, v23
    s_nop 1
    s_cmp_lt_u32 s52, s58
    s_cbranch_scc1 A_SLOW0
A_BACK0:
    s_add_u32 s58, s58, 8
    s_and_b32 s52, s56, 15
    s_mul_i32 s59, s52, 11264
    s_cmp_ge_u32 s57, 16
    s_cselect_b32 s59, 1073741824, s59
    s_add_u32 m0, s54, 33792
    s_add_u32 s60, s59, s61
    buffer_load_dwordx4 v139, s[36:39], s59 offen sc1 lds
    s_add_u32 m0, s55, 33792
    s_add_u32 s56, s56, 1
    buffer_load_dwordx4 v139, s[36:39], s60 offen sc1 lds
    s_add_u32 s57, s57, 1
    s_waitcnt lgkmcnt(2)
    v_mfma_f32_32x32x16_bf16 v[56:71], v[120:123], v[148:151], 0
    ds_read_b128 v[128:131], v138 offset:8192
    v_cvt_pk_bf16_f32 v110, v116, v117
    v_cvt_pk_bf16_f32 v111, v118, v119
    v_exp_f32 v112, v40
    v_exp_f32 v113, v41
    v_exp_f32 v114, v42
    v_exp_f32 v115, v43
    s_waitcnt lgkmcnt(2)
    v_mfma_f32_32x32x16_bf16 v[88:103], v[132:135], v[108:111], v[88:103]
    ds_read_b128 v[120:123], v136 offset:11264
    v_cvt_pk_bf16_f32 v104, v112, v113
    v_cvt_pk_bf16_f32 v105, v114, v115
    v_exp_f32 v116, v44
    v_exp_f32 v117, v45
    v_exp_f32 v118, v46
    v_exp_f32 v119, v47
    v_mfma_f32_32x32x16_bf16 v[56:71], v[124:127], v[156:159], v[56:71]
    ds_read_b128 v[132:135], v138 offset:8960
    v_cvt_pk_bf16_f32 v106, v116, v117
    v_cvt_pk_bf16_f32 v107, v118, v119
    v_exp_f32 v112, v48
    v_exp_f32 v113, v49
    v_exp_f32 v114, v50
    v_exp_f32 v115, v51
    s_waitcnt lgkmcnt(2)
    v_mfma_f32_32x32x16_bf16 v[88:103], v[128:131], v[104:107], v[88:103]
    ds_read_b64 v[124:125], v137 offset:15360
    v_cvt_pk_bf16_f32 v108, v112, v113
    v_cvt_pk_bf16_f32 v109, v114, v115
    v_exp_f32 v116, v52
    v_exp_f32 v117, v53
    v_exp_f32 v118, v54
    v_exp_f32 v119, v55
    s_setprio 2
    s_waitcnt lgkmcnt(2)
    v_mfma_f32_32x32x16_bf16 v[40:55], v[120:123], v[148:151], 0
    ds_read_b128 v[128:131], v138 offset:9728
    v_cvt_pk_bf16_f32 v110, v116, v117
    v_cvt_pk_bf16_f32 v111, v118, v119
    v_exp_f32 v112, v56
    v_exp_f32 v113, v57
    v_exp_f32 v114, v58
    v_exp_f32 v115, v59
    s_waitcnt lgkmcnt(2)
    v_mfma_f32_32x32x16_bf16 v[88:103], v[132:135], v[108:111], v[88:103]
    ds_read_b128 v[120:123], v136 offset:12288
    v_cvt_pk_bf16_f32 v104, v112, v113
    v_cvt_pk_bf16_f32 v105, v114, v115
    v_exp_f32 v116, v60
    v_exp_f32 v117, v61
    v_exp_f32 v118, v62
    v_exp_f32 v119, v63
    s_waitcnt lgkmcnt(2)
    v_mfma_f32_32x32x16_bf16 v[40:55], v[124:127], v[152:155], v[40:55]
    ds_read_b128 v[132:135], v138 offset:10496
    v_cvt_pk_bf16_f32 v106, v116, v117
    v_cvt_pk_bf16_f32 v107, v118, v119
    v_exp_f32 v112, v64
    v_exp_f32 v113, v65
    v_exp_f32 v114, v66
    v_exp_f32 v115, v67
    s_waitcnt lgkmcnt(2)
    v_mfma_f32_32x32x16_bf16 v[88:103], v[128:131], v[104:107], v[88:103]
    v_cvt_pk_bf16_f32 v108, v112, v113
    v_cvt_pk_bf16_f32 v109, v114, v115
    v_exp_f32 v116, v68
    v_exp_f32 v117, v69
    v_exp_f32 v118, v70
    v_exp_f32 v119, v71
    s_setprio 1
    s_waitcnt lgkmcnt(1)
    v_mfma_f32_32x32x16_bf16 v[56:71], v[120:123], v[148:151], 0
    ds_read_b128 v[128:131], v138 offset:16384
    v_cvt_pk_bf16_f32 v110, v116, v117
    v_cvt_pk_bf16_f32 v111, v118, v119
    v_exp_f32 v112, v40
    v_exp_f32 v113, v41
    v_exp_f32 v114, v42
    v_exp_f32 v115, v43
    s_waitcnt lgkmcnt(1)
    v_mfma_f32_32x32x16_bf16 v[88:103], v[132:135], v[108:111], v[88:103]
    ds_read_b128 v[120:123], v136 offset:13312
    s_waitcnt vmcnt(2)
    ds_add_u32 v13, v22 offset:272
    v_cvt_pk_bf16_f32 v104, v112, v113
    v_cvt_pk_bf16_f32 v105, v114, v115
    v_exp_f32 v116, v44
    v_exp_f32 v117, v45
    v_exp_f32 v118, v46
    v_exp_f32 v119, v47
    v_mfma_f32_32x32x16_bf16 v[56:71], v[124:127], v[156:159], v[56:71]
    ds_read_b128 v[132:135], v138 offset:17152
    v_cvt_pk_bf16_f32 v106, v116, v117
    v_cvt_pk_bf16_f32 v107, v118, v119
    v_exp_f32 v112, v48
    v_exp_f32 v113, v49
    v_exp_f32 v114, v50
    v_exp_f32 v115, v51
    s_waitcnt lgkmcnt(3)
    v_mfma_f32_32x32x16_bf16 v[88:103], v[128:131], v[104:107], v[88:103]
    ds_read_b64 v[124:125], v137 offset:15872
    v_cvt_pk_bf16_f32 v108, v112, v113
    v_cvt_pk_bf16_f32 v109, v114, v115
    v_exp_f32 v116, v52
    v_exp_f32 v117, v53
    v_exp_f32 v118, v54
    v_exp_f32 v119, v55
    s_setprio 0
    s_waitcnt lgkmcnt(3)
    v_mfma_f32_32x32x16_bf16 v[40:55], v[120:123], v[148:151], 0
    ds_read_b128 v[128:131], v138 offset:17920
    v_cvt_pk_bf16_f32 v110, v116, v117
    v_cvt_pk_bf16_f32 v111, v118, v119
    v_exp_f32 v112, v56
    v_exp_f32 v113, v57
    v_exp_f32 v114, v58
    v_exp_f32 v115, v59
    s_waitcnt lgkmcnt(2)
    v_mfma_f32_32x32x16_bf16 v[88:103], v[132:135], v[108:111], v[88:103]
    ds_read_b128 v[120:123], v136 offset:14336
    v_cvt_pk_bf16_f32 v104, v112, v113
    v_cvt_pk_bf16_f32 v105, v114, v115
    v_exp_f32 v116, v60
    v_exp_f32 v117, v61
    v_exp_f32 v118, v62
    v_exp_f32 v119, v63
    s_waitcnt lgkmcnt(2)
    v_mfma_f32_32x32x16_bf16 v[40:55], v[124:127], v[152:155], v[40:55]
    ds_read_b128 v[132:135], v138 offset:18688
    v_cvt_pk_bf16_f32 v106, v116, v117
    v_cvt_pk_bf16_f32 v107, v118, v119
    v_exp_f32 v112, v64
    v_exp_f32 v113, v65
    v_exp_f32 v114, v66
    v_exp_f32 v115, v67
    s_waitcnt lgkmcnt(2)
    v_mfma_f32_32x32x16_bf16 v[88:103], v[128:131], v[104:107], v[88:103]
    ds_read_b32 v23, v12 offset:272
    v_cvt_pk_bf16_f32 v108, v112, v113
    v_cvt_pk_bf16_f32 v109, v114, v115
    v_exp_f32 v116, v68
    v_exp_f32 v117, v69
    v_exp_f32 v118, v70
    v_exp_f32 v119, v71
    s_setprio 3
    s_waitcnt lgkmcnt(0)
    v_readfirstlane_b32 s52, v23
    s_nop 1
    s_cmp_lt_u32 s52, s58
    s_cbranch_scc1 A_SLOW1
A_BACK1:
    s_add_u32 s58, s58, 8
    s_and_b32 s52, s56, 15
    s_mul_i32 s59, s52, 11264
    s_cmp_ge_u32 s57, 16
    s_cselect_b32 s59, 1073741824, s59
    s_add_u32 m0, s54, 0
    s_add_u32 s60, s59, s61
    buffer_load_dwordx4 v139, s[36:39], s59 offen sc1 lds
    s_add_u32 m0, s55, 0
    s_add_u32 s56, s56, 1
    buffer_load_dwordx4 v139, s[36:39], s60 offen sc1 lds
    s_add_u32 s57, s57, 1
    s_waitcnt lgkmcnt(2)
    v_mfma_f32_32x32x16_bf16 v[56:71], v[120:123], v[148:151], 0
    ds_read_b128 v[128:131], v138 offset:19456
    v_cvt_pk_bf16_f32 v110, v116, v117
    v_cvt_pk_bf16_f32 v111, v118, v119
    v_exp_f32 v112, v40
    v_exp_f32 v113, v41
    v_exp_f32 v114, v42
    v_exp_f32 v115, v43
    s_waitcnt lgkmcnt(2)
    v_mfma_f32_32x32x16_bf16 v[88:103], v[132:135], v[108:111], v[88:103]
    ds_read_b128 v[120:123], v136 offset:22528
    v_cvt_pk_bf16_f32 v104, v112, v113
    v_cvt_pk_bf16_f32 v105, v114, v115
    v_exp_f32 v116, v44
    v_exp_f32 v117, v45
    v_exp_f32 v118, v46
    v_exp_f32 v119, v47
    v_mfma_f32_32x32x16_bf16 v[56:71], v[124:127], v[156:159], v[56:71]
    ds_read_b128 v[132:135], v138 offset:20224
    v_cvt_pk_bf16_f32 v106, v116, v117
    v_cvt_pk_bf16_f32 v107, v118, v119
    v_exp_f32 v112, v48
    v_exp_f32 v113, v49
    v_exp_f32 v114, v50
    v_exp_f32 v115, v51
    s_waitcnt lgkmcnt(2)
    v_mfma_f32_32x32x16_bf16 v[88:103], v[128:131], v[104:107], v[88:103]
    ds_read_b64 v[124:125], v137 offset:26624
    v_cvt_pk_bf16_f32 v108, v112, v113
    v_cvt_pk_bf16_f32 v109, v114, v115
    v_exp_f32 v116, v52
    v_exp_f32 v117, v53
    v_exp_f32 v118, v54
    v_exp_f32 v119, v55
    s_setprio 2
    s_waitcnt lgkmcnt(2)
    v_mfma_f32_32x32x16_bf16 v[40:55], v[120:123], v[148:151], 0
    ds_read_b128 v[128:131], v138 offset:20992
    v_cvt_pk_bf16_f32 v110, v116, v117
    v_cvt_pk_bf16_f32 v111, v118, v119
    v_exp_f32 v112, v56
    v_exp_f32 v113, v57
    v_exp_f32 v114, v58
    v_exp_f32 v115, v59
    s_waitcnt lgkmcnt(2)
    v_mfma_f32_32x32x16_bf16 v[88:103], v[132:135], v[108:111], v[88:103]
    ds_read_b128 v[120:123], v136 offset:23552
    v_cvt_pk_bf16_f32 v104, v112, v113
    v_cvt_pk_bf16_f32 v105, v114, v115
    v_exp_f32 v116, v60
    v_exp_f32 v117, v61
    v_exp_f32 v118, v62
    v_exp_f32 v119, v63
    s_waitcnt lgkmcnt(2)
    v_mfma_f32_32x32x16_bf16 v[40:55], v[124:127], v[152:155], v[40:55]
    ds_read_b128 v[132:135], v138 offset:21760
    v_cvt_pk_bf16_f32 v106, v116, v117
    v_cvt_pk_bf16_f32 v107, v118, v119
    v_exp_f32 v112, v64
    v_exp_f32 v113, v65
    v_exp_f32 v114, v66
    v_exp_f32 v115, v67
    s_waitcnt lgkmcnt(2)
    v_mfma_f32_32x32x16_bf16 v[88:103], v[128:131], v[104:107], v[88:103]
    v_cvt_pk_bf16_f32 v108, v112, v113
    v_cvt_pk_bf16_f32 v109, v114, v115
    v_exp_f32 v116, v68
    v_exp_f32 v117, v69
    v_exp_f32 v118, v70
    v_exp_f32 v119, v71
    s_setprio 1
    s_waitcnt lgkmcnt(1)
    v_mfma_f32_32x32x16_bf16 v[56:71], v[120:123], v[148:151], 0
    ds_read_b128 v[128:131], v138 offset:27648
    v_cvt_pk_bf16_f32 v110, v116, v117
    v_cvt_pk_bf16_f32 v111, v118, v119
    v_exp_f32 v112, v40
    v_exp_f32 v113, v41
    v_exp_f32 v114, v42
    v_exp_f32 v115, v43
    s_waitcnt lgkmcnt(1)
    v_mfma_f32_32x32x16_bf16 v[88:103], v[132:135], v[108:111], v[88:103]
    ds_read_b128 v[120:123], v136 offset:24576
    s_waitcnt vmcnt(2)
    ds_add_u32 v13, v22 offset:272
    v_cvt_pk_bf16_f32 v104, v112, v113
    v_cvt_pk_bf16_f32 v105, v114, v115
    v_exp_f32 v116, v44
    v_exp_f32 v117, v45
    v_exp_f32 v118, v46
    v_exp_f32 v119, v47
    v_mfma_f32_32x32x16_bf16 v[56:71], v[124:127], v[156:159], v[56:71]
    ds_read_b128 v[132:135], v138 offset:28416
    v_cvt_pk_bf16_f32 v106, v116, v117
    v_cvt_pk_bf16_f32 v107, v118, v119
    v_exp_f32 v112, v48
    v_exp_f32 v113, v49
    v_exp_f32 v114, v50
    v_exp_f32 v115, v51
    s_waitcnt lgkmcnt(3)
    v_mfma_f32_32x32x16_bf16 v[88:103], v[128:131], v[104:107], v[88:103]
    ds_read_b64 v[124:125], v137 offset:27136
    v_cvt_pk_bf16_f32 v108, v112, v113
    v_cvt_pk_bf16_f32 v109, v114, v115
    v_exp_f32 v116, v52
    v_exp_f32 v117, v53
    v_exp_f32 v118, v54
    v_exp_f32 v119, v55
    s_setprio 0
    s_waitcnt lgkmcnt(3)
    v_mfma_f32_32x32x16_bf16 v[40:55], v[120:123], v[148:151], 0
    ds_read_b128 v[128:131], v138 offset:29184
    v_cvt_pk_bf16_f32 v110, v116, v117
    v_cvt_pk_bf16_f32 v111, v118, v119
    v_exp_f32 v112, v56
    v_exp_f32 v113, v57
    v_exp_f32 v114, v58
    v_exp_f32 v115, v59
    s_waitcnt lgkmcnt(2)
    v_mfma_f32_32x32x16_bf16 v[88:103], v[132:135], v[108:111], v[88:103]
    ds_read_b128 v[120:123], v136 offset:25600
    v_cvt_pk_bf16_f32 v104, v112, v113
    v_cvt_pk_bf16_f32 v105, v114, v115
    v_exp_f32 v116, v60
    v_exp_f32 v117, v61
    v_exp_f32 v118, v62
    v_exp_f32 v119, v63
    s_waitcnt lgkmcnt(2)
    v_mfma_f32_32x32x16_bf16 v[40:55], v[124:127], v[152:155], v[40:55]
    ds_read_b128 v[132:135], v138 offset:29952
    v_cvt_pk_bf16_f32 v106, v116, v117
    v_cvt_pk_bf16_f32 v107, v118, v119
    v_exp_f32 v112, v64
    v_exp_f32 v113, v65
    v_exp_f32 v114, v66
    v_exp_f32 v115, v67
    s_waitcnt lgkmcnt(2)
    v_mfma_f32_32x32x16_bf16 v[88:103], v[128:131], v[104:107], v[88:103]
    ds_read_b32 v23, v12 offset:272
    v_cvt_pk_bf16_f32 v108, v112, v113
    v_cvt_pk_bf16_f32 v109, v114, v115
    v_exp_f32 v116, v68
    v_exp_f32 v117, v69
    v_exp_f32 v118, v70
    v_exp_f32 v119, v71
    s_setprio 3
    s_waitcnt lgkmcnt(0)
    v_readfirstlane_b32 s52, v23
    s_nop 1
    s_cmp_lt_u32 s52, s58
    s_cbranch_scc1 A_SLOW2
A_BACK2:
    s_add_u32 s58, s58, 8
    s_and_b32 s52, s56, 15
    s_mul_i32 s59, s52, 11264
    s_cmp_ge_u32 s57, 16
    s_cselect_b32 s59, 1073741824, s59
    s_add_u32 m0, s54, 11264
    s_add_u32 s60, s59, s61
    buffer_load_dwordx4 v139, s[36:39], s59 offen sc1 lds
    s_add_u32 m0, s55, 11264
    s_add_u32 s56, s56, 1
    buffer_load_dwordx4 v139, s[36:39], s60 offen sc1 lds
    s_add_u32 s57, s57, 1
    s_waitcnt lgkmcnt(2)
    v_mfma_f32_32x32x16_bf16 v[56:71], v[120:123], v[148:151], 0
    ds_read_b128 v[128:131], v138 offset:30720
    v_cvt_pk_bf16_f32 v110, v116, v117
    v_cvt_pk_bf16_f32 v111, v118, v119
    v_exp_f32 v112, v40
    v_exp_f32 v113, v41
    v_exp_f32 v114, v42
    v_exp_f32 v115, v43
    s_waitcnt lgkmcnt(2)
    v_mfma_f32_32x32x16_bf16 v[88:103], v[132:135], v[108:111], v[88:103]
    ds_read_b128 v[120:123], v136 offset:33792
    v_cvt_pk_bf16_f32 v104, v112, v113
    v_cvt_pk_bf16_f32 v105, v114, v115
    v_exp_f32 v116, v44
    v_exp_f32 v117, v45
    v_exp_f32 v118, v46
    v_exp_f32 v119, v47
    v_mfma_f32_32x32x16_bf16 v[56:71], v[124:127], v[156:159], v[56:71]
    ds_read_b128 v[132:135], v138 offset:31488
    v_cvt_pk_bf16_f32 v106, v116, v117
    v_cvt_pk_bf16_f32 v107, v118, v119
    v_exp_f32 v112, v48
    v_exp_f32 v113, v49
    v_exp_f32 v114, v50
    v_exp_f32 v115, v51
    s_waitcnt lgkmcnt(2)
    v_mfma_f32_32x32x16_bf16 v[88:103], v[128:131], v[104:107], v[88:103]
    ds_read_b64 v[124:125], v137 offset:37888
    v_cvt_pk_bf16_f32 v108, v112, v113
    v_cvt_pk_bf16_f32 v109, v114, v115
    v_exp_f32 v116, v52
    v_exp_f32 v117, v53
    v_exp_f32 v118, v54
    v_exp_f32 v119, v55
    s_setprio 2
    s_waitcnt lgkmcnt(2)
    v_mfma_f32_32x32x16_bf16 v[40:55], v[120:123], v[148:151], 0
    ds_read_b128 v[128:131], v138 offset:32256
    v_cvt_pk_bf16_f32 v110, v116, v117
    v_cvt_pk_bf16_f32 v111, v118, v119
    v_exp_f32 v112, v56
    v_exp_f32 v113, v57
    v_exp_f32 v114, v58
    v_exp_f32 v115, v59
    s_waitcnt lgkmcnt(2)
    v_mfma_f32_32x32x16_bf16 v[88:103], v[132:135], v[108:111], v[88:103]
    ds_read_b128 v[120:123], v136 offset:34816
    v_cvt_pk_bf16_f32 v104, v112, v113
    v_cvt_pk_bf16_f32 v105, v114, v115
    v_exp_f32 v116, v60
    v_exp_f32 v117, v61
    v_exp_f32 v118, v62
    v_exp_f32 v119, v63
    s_waitcnt lgkmcnt(2)
    v_mfma_f32_32x32x16_bf16 v[40:55], v[124:127], v[152:155], v[40:55]
    ds_read_b128 v[132:135], v138 offset:33024
    v_cvt_pk_bf16_f32 v106, v116, v117
    v_cvt_pk_bf16_f32 v107, v118, v119
    v_exp_f32 v112, v64
    v_exp_f32 v113, v65
    v_exp_f32 v114, v66
    v_exp_f32 v115, v67
    s_waitcnt lgkmcnt(2)
    v_mfma_f32_32x32x16_bf16 v[88:103], v[128:131], v[104:107], v[88:103]
    v_cvt_pk_bf16_f32 v108, v112, v113
    v_cvt_pk_bf16_f32 v109, v114, v115
    v_exp_f32 v116, v68
    v_exp_f32 v117, v69
    v_exp_f32 v118, v70
    v_exp_f32 v119, v71
    s_setprio 1
    s_waitcnt lgkmcnt(1)
    v_mfma_f32_32x32x16_bf16 v[56:71], v[120:123], v[148:151], 0
    ds_read_b128 v[128:131], v138 offset:38912
    v_cvt_pk_bf16_f32 v110, v116, v117
    v_cvt_pk_bf16_f32 v111, v118, v119
    v_exp_f32 v112, v40
    v_exp_f32 v113, v41
    v_exp_f32 v114, v42
    v_exp_f32 v115, v43
    s_waitcnt lgkmcnt(1)
    v_mfma_f32_32x32x16_bf16 v[88:103], v[132:135], v[108:111], v[88:103]
    ds_read_b128 v[120:123], v136 offset:35840
    s_waitcnt vmcnt(2)
    ds_add_u32 v13, v22 offset:272
    v_cvt_pk_bf16_f32 v104, v112, v113
    v_cvt_pk_bf16_f32 v105, v114, v115
    v_exp_f32 v116, v44
    v_exp_f32 v117, v45
    v_exp_f32 v118, v46
    v_exp_f32 v119, v47
    v_mfma_f32_32x32x16_bf16 v[56:71], v[124:127], v[156:159], v[56:71]
    ds_read_b128 v[132:135], v138 offset:39680
    v_cvt_pk_bf16_f32 v106, v116, v117
    v_cvt_pk_bf16_f32 v107, v118, v119
    v_exp_f32 v112, v48
    v_exp_f32 v113, v49
    v_exp_f32 v114, v50
    v_exp_f32 v115, v51
    s_waitcnt lgkmcnt(3)
    v_mfma_f32_32x32x16_bf16 v[88:103], v[128:131], v[104:107], v[88:103]
    ds_read_b64 v[124:125], v137 offset:38400
    v_cvt_pk_bf16_f32 v108, v112, v113
    v_cvt_pk_bf16_f32 v109, v114, v115
    v_exp_f32 v116, v52
    v_exp_f32 v117, v53
    v_exp_f32 v118, v54
    v_exp_f32 v119, v55
    s_setprio 0
    s_waitcnt lgkmcnt(3)
    v_mfma_f32_32x32x16_bf16 v[40:55], v[120:123], v[148:151], 0
    ds_read_b128 v[128:131], v138 offset:40448
    v_cvt_pk_bf16_f32 v110, v116, v117
    v_cvt_pk_bf16_f32 v111, v118, v119
    v_exp_f32 v112, v56
    v_exp_f32 v113, v57
    v_exp_f32 v114, v58
    v_exp_f32 v115, v59
    s_waitcnt lgkmcnt(2)
    v_mfma_f32_32x32x16_bf16 v[88:103], v[132:135], v[108:111], v[88:103]
    ds_read_b128 v[120:123], v136 offset:36864
    v_cvt_pk_bf16_f32 v104, v112, v113
    v_cvt_pk_bf16_f32 v105, v114, v115
    v_exp_f32 v116, v60
    v_exp_f32 v117, v61
    v_exp_f32 v118, v62
    v_exp_f32 v119, v63
    s_waitcnt lgkmcnt(2)
    v_mfma_f32_32x32x16_bf16 v[40:55], v[124:127], v[152:155], v[40:55]
    ds_read_b128 v[132:135], v138 offset:41216
    v_cvt_pk_bf16_f32 v106, v116, v117
    v_cvt_pk_bf16_f32 v107, v118, v119
    v_exp_f32 v112, v64
    v_exp_f32 v113, v65
    v_exp_f32 v114, v66
    v_exp_f32 v115, v67
    s_waitcnt lgkmcnt(2)
    v_mfma_f32_32x32x16_bf16 v[88:103], v[128:131], v[104:107], v[88:103]
    ds_read_b32 v23, v12 offset:272
    v_cvt_pk_bf16_f32 v108, v112, v113
    v_cvt_pk_bf16_f32 v109, v114, v115
    v_exp_f32 v116, v68
    v_exp_f32 v117, v69
    v_exp_f32 v118, v70
    v_exp_f32 v119, v71
    s_setprio 3
    s_waitcnt lgkmcnt(0)
    v_readfirstlane_b32 s52, v23
    s_nop 1
    s_cmp_lt_u32 s52, s58
    s_cbranch_scc1 A_SLOW3
A_BACK3:
    s_add_u32 s58, s58, 8
    s_and_b32 s52, s56, 15
    s_mul_i32 s59, s52, 11264
    s_cmp_ge_u32 s57, 16
    s_cselect_b32 s59, 1073741824, s59
    s_add_u32 m0, s54, 22528
    s_add_u32 s60, s59, s61
    buffer_load_dwordx4 v139, s[36:39], s59 offen sc1 lds
    s_add_u32 m0, s55, 22528
    s_add_u32 s56, s56, 1
    buffer_load_dwordx4 v139, s[36:39], s60 offen sc1 lds
    s_add_u32 s57, s57, 1
    s_waitcnt lgkmcnt(2)
    v_mfma_f32_32x32x16_bf16 v[56:71], v[120:123], v[148:151], 0
    ds_read_b128 v[128:131], v138 offset:41984
    v_cvt_pk_bf16_f32 v110, v116, v117
    v_cvt_pk_bf16_f32 v111, v118, v119
    v_exp_f32 v112, v40
    v_exp_f32 v113, v41
    v_exp_f32 v114, v42
    v_exp_f32 v115, v43
    s_waitcnt lgkmcnt(2)
    v_mfma_f32_32x32x16_bf16 v[88:103], v[132:135], v[108:111], v[88:103]
    ds_read_b128 v[120:123], v136 offset:0
    v_cvt_pk_bf16_f32 v104, v112, v113
    v_cvt_pk_bf16_f32 v105, v114, v115
    v_exp_f32 v116, v44
    v_exp_f32 v117, v45
    v_exp_f32 v118, v46
    v_exp_f32 v119, v47
    v_mfma_f32_32x32x16_bf16 v[56:71], v[124:127], v[156:159], v[56:71]
    ds_read_b128 v[132:135], v138 offset:42752
    v_cvt_pk_bf16_f32 v106, v116, v117
    v_cvt_pk_bf16_f32 v107, v118, v119
    v_exp_f32 v112, v48
    v_exp_f32 v113, v49
    v_exp_f32 v114, v50
    v_exp_f32 v115, v51
    s_waitcnt lgkmcnt(2)
    v_mfma_f32_32x32x16_bf16 v[88:103], v[128:131], v[104:107], v[88:103]
    ds_read_b64 v[124:125], v137 offset:4096
    v_cvt_pk_bf16_f32 v108, v112, v113
    v_cvt_pk_bf16_f32 v109, v114, v115
    v_exp_f32 v116, v52
    v_exp_f32 v117, v53
    v_exp_f32 v118, v54
    v_exp_f32 v119, v55
    s_setprio 2
    s_waitcnt lgkmcnt(2)
    v_mfma_f32_32x32x16_bf16 v[40:55], v[120:123], v[148:151], 0
    ds_read_b128 v[128:131], v138 offset:43520
    v_cvt_pk_bf16_f32 v110, v116, v117
    v_cvt_pk_bf16_f32 v111, v118, v119
    v_exp_f32 v112, v56
    v_exp_f32 v113, v57
    v_exp_f32 v114, v58
    v_exp_f32 v115, v59
    s_waitcnt lgkmcnt(2)
    v_mfma_f32_32x32x16_bf16 v[88:103], v[132:135], v[108:111], v[88:103]
    ds_read_b128 v[120:123], v136 offset:1024
    v_cvt_pk_bf16_f32 v104, v112, v113
    v_cvt_pk_bf16_f32 v105, v114, v115
    v_exp_f32 v116, v60
    v_exp_f32 v117, v61
    v_exp_f32 v118, v62
    v_exp_f32 v119, v63
    s_waitcnt lgkmcnt(2)
    v_mfma_f32_32x32x16_bf16 v[40:55], v[124:127], v[152:155], v[40:55]
    ds_read_b128 v[132:135], v138 offset:44288
    v_cvt_pk_bf16_f32 v106, v116, v117
    v_cvt_pk_bf16_f32 v107, v118, v119
    v_exp_f32 v112, v64
    v_exp_f32 v113, v65
    v_exp_f32 v114, v66
    v_exp_f32 v115, v67
    s_waitcnt lgkmcnt(2)
    v_mfma_f32_32x32x16_bf16 v[88:103], v[128:131], v[104:107], v[88:103]
    v_cvt_pk_bf16_f32 v108, v112, v113
    v_cvt_pk_bf16_f32 v109, v114, v115
    v_exp_f32 v116, v68
    v_exp_f32 v117, v69
    v_exp_f32 v118, v70
    v_exp_f32 v119, v71
    s_cmp_lt_u32 s57, 19
    s_cbranch_scc1 A_LOOP
    v_cvt_pk_bf16_f32 v110, v116, v117
    v_cvt_pk_bf16_f32 v111, v118, v119
    s_waitcnt vmcnt(0) lgkmcnt(0)
    ds_add_u32 v13, v22 offset:352
    s_nop 1
    v_mfma_f32_32x32x16_bf16 v[88:103], v[132:135], v[108:111], v[88:103]
    s_lshl_b32 s54, s48, 1
    s_add_u32 s54, s54, s15
    s_mul_i32 s54, s54, 40960
    s_mul_i32 s52, s49, 5120
    s_add_u32 s54, s54, s52
    s_add_u32 s54, s54, 16777216
    s_and_b32 s52, s50, 3
    s_lshl_b32 s55, s52, 8
    s_add_u32 s55, s55, s54
    s_add_u32 s55, s55, 4096
    s_lshl_b32 s52, s52, 10
    s_add_u32 s54, s54, s52
    v_lshlrev_b32 v4, 31, v7
    v_or_b32 v4, v4, v137
    s_mov_b32 s62, 0
A_NORM:
    v_mov_b32 v2, v96
    v_mov_b32 v3, v96
    s_nop 1
    v_permlane32_swap_b32 v2, v3
    s_nop 1
    v_rcp_f32 v2, v3
    v_cmp_nle_f32 vcc, 0x0a800000, v3
    v_mov_b32 v5, 0x7b800000
    v_cmp_nle_f32 s[56:57], v3, v5
    v_mul_f32 v88, v2, v88
    v_mul_f32 v89, v2, v89
    v_mul_f32 v90, v2, v90
    v_mul_f32 v91, v2, v91
    v_mul_f32 v92, v2, v92
    v_mul_f32 v93, v2, v93
    v_mul_f32 v94, v2, v94
    v_mul_f32 v95, v2, v95
    v_mul_f32 v96, v2, v96
    v_mul_f32 v97, v2, v97
    v_mul_f32 v98, v2, v98
    v_mul_f32 v99, v2, v99
    s_or_b64 s[56:57], s[56:57], vcc
    v_mul_f32 v5, 0, v88
    v_fmac_f32 v5, 0, v89
    v_fmac_f32 v5, 0, v90
    v_fmac_f32 v5, 0, v91
    v_fmac_f32 v5, 0, v92
    v_fmac_f32 v5, 0, v93
    v_fmac_f32 v5, 0, v94
    v_fmac_f32 v5, 0, v95
    v_fmac_f32 v5, 0, v96
    v_fmac_f32 v5, 0, v97
    v_fmac_f32 v5, 0, v98
    v_fmac_f32 v5, 0, v99
    v_cmp_u_f32 vcc, v5, v5
    s_nop 1
    s_or_b64 vcc, vcc, s[56:57]
    s_cmp_eq_u64 vcc, 0
    s_cbranch_scc0 A_FB
A_ST:
    v_cvt_pk_bf16_f32 v104, v88, v89
    v_cvt_pk_bf16_f32 v105, v90, v91
    v_cvt_pk_bf16_f32 v106, v92, v93
    v_cvt_pk_bf16_f32 v107, v94, v95
    v_cvt_pk_bf16_f32 v108, v96, v97
    v_cvt_pk_bf16_f32 v109, v98, v99
    buffer_store_dwordx4 v[104:107], v136, s[44:47], s54 offen sc1
    buffer_store_dwordx2 v[108:109], v4, s[44:47], s55 offen sc1
    s_lshl_b32 s54, s48, 13
    s_lshl_b32 s52, s15, 12
    s_add_u32 s54, s54, s52
    s_lshl_b32 s52, s49, 9
    s_add_u32 s54, s54, s52
    s_and_b32 s52, s50, 3
    s_lshl_b32 s52, s52, 7
    s_add_u32 s54, s54, s52
    s_add_u32 s54, s54, 21233664
    s_waitcnt vmcnt(0)
    v_mov_b32 v2, s30
    v_mov_b32 v3, s31
    v_lshlrev_b32 v4, 3, v1
    s_mov_b64 exec, 0xffff
    buffer_store_dwordx2 v[2:3], v4, s[44:47], s54 offen sc1
    s_mov_b64 exec, -1
    ds_add_u32 v13, v22 offset:352
    s_endpgm
A_FB:
    s_cmp_lg_u32 s62, 0
    s_cbranch_scc1 A_ST
    s_mov_b32 s62, 1
    v_mov_b32 v154, 0
    v_mov_b32 v158, 0
    v_mov_b32 v140, 0xff800000
    s_mov_b32 s58, 0
FBL_45:
    s_lshr_b32 s52, s58, 1
    s_mul_i32 s59, s52, 11264
    s_and_b32 s52, s58, 1
    s_lshl_b32 s60, s52, 11
    s_add_u32 s60, s60, s59
    s_lshl_b32 s61, s52, 9
    s_add_u32 s61, s61, s59
    s_add_u32 s61, s61, 4096
    s_mul_i32 s52, s52, 3072
    s_add_u32 s59, s59, s52
    s_add_u32 s59, s59, 5120
    buffer_load_dwordx2 v[124:125], v137, s[36:39], s61 offen sc1
    buffer_load_dwordx4 v[120:123], v136, s[36:39], s60 offen offset:0 sc1
    s_waitcnt vmcnt(0)
    v_mfma_f32_32x32x16_bf16 v[40:55], v[120:123], v[148:151], 0
    v_mfma_f32_32x32x16_bf16 v[40:55], v[124:127], v[152:155], v[40:55]
    s_nop 15
    v_max3_f32 v140, v40, v41, v140
    v_max3_f32 v140, v42, v43, v140
    v_max3_f32 v140, v44, v45, v140
    v_max3_f32 v140, v46, v47, v140
    v_max3_f32 v140, v48, v49, v140
    v_max3_f32 v140, v50, v51, v140
    v_max3_f32 v140, v52, v53, v140
    v_max3_f32 v140, v54, v55, v140
    buffer_load_dwordx4 v[120:123], v136, s[36:39], s60 offen offset:1024 sc1
    s_waitcnt vmcnt(0)
    v_mfma_f32_32x32x16_bf16 v[56:71], v[120:123], v[148:151], 0
    v_mfma_f32_32x32x16_bf16 v[56:71], v[124:127], v[156:159], v[56:71]
    s_nop 15
    v_max3_f32 v140, v56, v57, v140
    v_max3_f32 v140, v58, v59, v140
    v_max3_f32 v140, v60, v61, v140
    v_max3_f32 v140, v62, v63, v140
    v_max3_f32 v140, v64, v65, v140
    v_max3_f32 v140, v66, v67, v140
    v_max3_f32 v140, v68, v69, v140
    v_max3_f32 v140, v70, v71, v140
    s_add_u32 s58, s58, 1
    s_cmp_lt_u32 s58, 32
    s_cbranch_scc1 FBL_45
    v_mov_b32 v2, v140
    s_nop 1
    v_permlane32_swap_b32 v2, v140
    s_nop 1
    v_max_f32 v140, v140, v2
    v_sub_f32 v140, 0, v140
    v_and_b32 v2, 0xffff0000, v140
    v_sub_f32 v3, v140, v2
    v_cvt_pk_bf16_f32 v140, v2, v3
    v_cmp_eq_u32 vcc, 0, v7
    v_mov_b32 v88, 0
    v_mov_b32 v89, 0
    v_mov_b32 v90, 0
    v_mov_b32 v91, 0
    v_mov_b32 v92, 0
    v_mov_b32 v93, 0
    v_mov_b32 v94, 0
    v_mov_b32 v95, 0
    v_mov_b32 v96, 0
    v_mov_b32 v97, 0
    v_mov_b32 v98, 0
    v_mov_b32 v99, 0
    v_mov_b32 v100, 0
    v_mov_b32 v101, 0
    v_mov_b32 v102, 0
    v_mov_b32 v103, 0
    v_cndmask_b32 v154, 0, v140, vcc
    v_cndmask_b32 v158, v140, 0, vcc
    s_mov_b32 s58, 0
FBL_46:
    s_lshr_b32 s52, s58, 1
    s_mul_i32 s59, s52, 11264
    s_and_b32 s52, s58, 1
    s_lshl_b32 s60, s52, 11
    s_add_u32 s60, s60, s59
    s_lshl_b32 s61, s52, 9
    s_add_u32 s61, s61, s59
    s_add_u32 s61, s61, 4096
    s_mul_i32 s52, s52, 3072
    s_add_u32 s59, s59, s52
    s_add_u32 s59, s59, 5120
    buffer_load_dwordx2 v[124:125], v137, s[36:39], s61 offen sc1
    buffer_load_dwordx4 v[120:123], v136, s[36:39], s60 offen offset:0 sc1
    buffer_load_dwordx4 v[128:131], v138, s[36:39], s59 offen offset:0 sc1
    buffer_load_dwordx4 v[132:135], v138, s[36:39], s59 offen offset:768 sc1
    s_waitcnt vmcnt(0)
    v_mfma_f32_32x32x16_bf16 v[40:55], v[120:123], v[148:151], 0
    v_mfma_f32_32x32x16_bf16 v[40:55], v[124:127], v[152:155], v[40:55]
    s_nop 15
    v_exp_f32 v112, v40
    v_exp_f32 v113, v41
    v_exp_f32 v114, v42
    v_exp_f32 v115, v43
    s_nop 0
    v_cvt_pk_bf16_f32 v104, v112, v113
    v_cvt_pk_bf16_f32 v105, v114, v115
    v_exp_f32 v116, v44
    v_exp_f32 v117, v45
    v_exp_f32 v118, v46
    v_exp_f32 v119, v47
    s_nop 0
    v_cvt_pk_bf16_f32 v106, v116, v117
    v_cvt_pk_bf16_f32 v107, v118, v119
    v_exp_f32 v112, v48
    v_exp_f32 v113, v49
    v_exp_f32 v114, v50
    v_exp_f32 v115, v51
    s_nop 0
    v_cvt_pk_bf16_f32 v108, v112, v113
    v_cvt_pk_bf16_f32 v109, v114, v115
    v_exp_f32 v116, v52
    v_exp_f32 v117, v53
    v_exp_f32 v118, v54
    v_exp_f32 v119, v55
    s_nop 0
    v_cvt_pk_bf16_f32 v110, v116, v117
    v_cvt_pk_bf16_f32 v111, v118, v119
    s_nop 1
    v_mfma_f32_32x32x16_bf16 v[88:103], v[128:131], v[104:107], v[88:103]
    v_mfma_f32_32x32x16_bf16 v[88:103], v[132:135], v[108:111], v[88:103]
    s_nop 7
    buffer_load_dwordx4 v[120:123], v136, s[36:39], s60 offen offset:1024 sc1
    buffer_load_dwordx4 v[128:131], v138, s[36:39], s59 offen offset:1536 sc1
    buffer_load_dwordx4 v[132:135], v138, s[36:39], s59 offen offset:2304 sc1
    s_waitcnt vmcnt(0)
    v_mfma_f32_32x32x16_bf16 v[56:71], v[120:123], v[148:151], 0
    v_mfma_f32_32x32x16_bf16 v[56:71], v[124:127], v[156:159], v[56:71]
    s_nop 15
    v_exp_f32 v112, v56
    v_exp_f32 v113, v57
    v_exp_f32 v114, v58
    v_exp_f32 v115, v59
    s_nop 0
    v_cvt_pk_bf16_f32 v104, v112, v113
    v_cvt_pk_bf16_f32 v105, v114, v115
    v_exp_f32 v116, v60
    v_exp_f32 v117, v61
    v_exp_f32 v118, v62
    v_exp_f32 v119, v63
    s_nop 0
    v_cvt_pk_bf16_f32 v106, v116, v117
    v_cvt_pk_bf16_f32 v107, v118, v119
    v_exp_f32 v112, v64
    v_exp_f32 v113, v65
    v_exp_f32 v114, v66
    v_exp_f32 v115, v67
    s_nop 0
    v_cvt_pk_bf16_f32 v108, v112, v113
    v_cvt_pk_bf16_f32 v109, v114, v115
    v_exp_f32 v116, v68
    v_exp_f32 v117, v69
    v_exp_f32 v118, v70
    v_exp_f32 v119, v71
    s_nop 0
    v_cvt_pk_bf16_f32 v110, v116, v117
    v_cvt_pk_bf16_f32 v111, v118, v119
    s_nop 1
    v_mfma_f32_32x32x16_bf16 v[88:103], v[128:131], v[104:107], v[88:103]
    v_mfma_f32_32x32x16_bf16 v[88:103], v[132:135], v[108:111], v[88:103]
    s_nop 7
    s_add_u32 s58, s58, 1
    s_cmp_lt_u32 s58, 32
    s_cbranch_scc1 FBL_46
    s_nop 15
    s_branch A_NORM
A_SLOW0:
    s_mov_b32 s63, 1600000
LW_47:
    ds_read_b32 v23, v12 offset:272
    s_waitcnt lgkmcnt(0)
    v_readfirstlane_b32 s52, v23
    s_nop 1
    s_cmp_ge_u32 s52, s58
    s_cbranch_scc1 LWD_48
    s_sleep 1
    s_sub_u32 s63, s63, 1
    s_cmp_lg_u32 s63, 0
    s_cbranch_scc1 LW_47
LWD_48:
    s_branch A_BACK0
A_SLOW1:
    s_mov_b32 s63, 1600000
LW_49:
    ds_read_b32 v23, v12 offset:272
    s_waitcnt lgkmcnt(0)
    v_readfirstlane_b32 s52, v23
    s_nop 1
    s_cmp_ge_u32 s52, s58
    s_cbranch_scc1 LWD_50
    s_sleep 1
    s_sub_u32 s63, s63, 1
    s_cmp_lg_u32 s63, 0
    s_cbranch_scc1 LW_49
LWD_50:
    s_branch A_BACK1
A_SLOW2:
    s_mov_b32 s63, 1600000
LW_51:
    ds_read_b32 v23, v12 offset:272
    s_waitcnt lgkmcnt(0)
    v_readfirstlane_b32 s52, v23
    s_nop 1
    s_cmp_ge_u32 s52, s58
    s_cbranch_scc1 LWD_52
    s_sleep 1
    s_sub_u32 s63, s63, 1
    s_cmp_lg_u32 s63, 0
    s_cbranch_scc1 LW_51
LWD_52:
    s_branch A_BACK2
A_SLOW3:
    s_mov_b32 s63, 1600000
LW_53:
    ds_read_b32 v23, v12 offset:272
    s_waitcnt lgkmcnt(0)
    v_readfirstlane_b32 s52, v23
    s_nop 1
    s_cmp_ge_u32 s52, s58
    s_cbranch_scc1 LWD_54
    s_sleep 1
    s_sub_u32 s63, s63, 1
    s_cmp_lg_u32 s63, 0
    s_cbranch_scc1 LW_53
LWD_54:
    s_branch A_BACK3
F_GEMM:
    s_sub_u32 s61, s50, 8
    v_lshlrev_b32 v22, 4, v1
    s_cmp_ge_u32 s50, 10
    s_cbranch_scc1 G_LOAD
    s_setprio 2
    v_mov_b32 v2, 0
    s_mov_b32 s54, 21495808
    buffer_load_dwordx2 v[20:21], v2, s[44:47], s54 offen sc1
    s_xor_b32 s52, s48, s49
    s_bitcmp0_b32 s52, 2
    s_cbranch_scc1 G_KV
    s_waitcnt vmcnt(0)
    v_add_co_u32 v20, vcc, 0x7f4a7c14, v20
    v_mov_b32 v3, 0x9e3779b9
    s_nop 0
    v_addc_co_u32 v21, vcc, v21, v3, vcc
    s_nop 0
    v_readfirstlane_b32 s30, v20
    v_readfirstlane_b32 s31, v21
    ds_write_b64 v12, v[20:21] offset:256
    v_mov_b32 v3, 1
    ds_add_u32 v13, v3 offset:340
    ds_add_u32 v13, v3 offset:288
    s_branch G_FFN1
G_KV:
    s_bfe_u32 s15, s49, 0x10001
    s_and_b32 s60, s49, 1
    s_cmp_eq_u32 s15, 0
    s_cselect_b32 s32, s8, s10
    s_cselect_b32 s33, s9, s11
    s_mov_b32 s34, 25600
    s_mov_b32 s35, 0x20000
    s_mul_i32 s54, s62, 2560
    s_mul_i32 s55, s61, 12800
    s_add_u32 s54, s54, s55
    s_add_u32 s55, s55, 137216
    s_mov_b32 s63, 1600000
LW_55:
    ds_read_b32 v2, v12 offset:344
    s_waitcnt lgkmcnt(0)
    v_readfirstlane_b32 s52, v2
    s_nop 1
    s_cmp_ge_u32 s52, 4
    s_cbranch_scc1 LWD_56
    s_sleep 1
    s_sub_u32 s63, s63, 1
    s_cmp_lg_u32 s63, 0
    s_cbranch_scc1 LW_55
LWD_56:
    v_add_u32 v2, s54, v22
    v_subrev_u32 v3, 25600, v2
    v_min_u32 v3, v3, v2
    s_add_u32 m0, s55, 0
    v_add_u32 v2, 1024, v2
    buffer_load_dwordx4 v3, s[32:35], 0 offen lds
    v_subrev_u32 v3, 25600, v2
    v_min_u32 v3, v3, v2
    s_add_u32 m0, s55, 1024
    v_add_u32 v2, 1024, v2
    buffer_load_dwordx4 v3, s[32:35], 0 offen lds
    v_subrev_u32 v3, 25600, v2
    v_min_u32 v3, v3, v2
    s_add_u32 m0, s55, 2048
    v_add_u32 v2, 1024, v2
    buffer_load_dwordx4 v3, s[32:35], 0 offen lds
    v_subrev_u32 v3, 25600, v2
    v_min_u32 v3, v3, v2
    s_add_u32 m0, s55, 3072
    v_add_u32 v2, 1024, v2
    buffer_load_dwordx4 v3, s[32:35], 0 offen lds
    v_subrev_u32 v3, 25600, v2
    v_min_u32 v3, v3, v2
    s_add_u32 m0, s55, 4096
    v_add_u32 v2, 1024, v2
    buffer_load_dwordx4 v3, s[32:35], 0 offen lds
    v_subrev_u32 v3, 25600, v2
    v_min_u32 v3, v3, v2
    s_add_u32 m0, s55, 5120
    v_add_u32 v2, 1024, v2
    buffer_load_dwordx4 v3, s[32:35], 0 offen lds
    v_subrev_u32 v3, 25600, v2
    v_min_u32 v3, v3, v2
    s_add_u32 m0, s55, 6144
    v_add_u32 v2, 1024, v2
    buffer_load_dwordx4 v3, s[32:35], 0 offen lds
    v_subrev_u32 v3, 25600, v2
    v_min_u32 v3, v3, v2
    s_add_u32 m0, s55, 7168
    v_add_u32 v2, 1024, v2
    buffer_load_dwordx4 v3, s[32:35], 0 offen lds
    v_subrev_u32 v3, 25600, v2
    v_min_u32 v3, v3, v2
    s_add_u32 m0, s55, 8192
    v_add_u32 v2, 1024, v2
    buffer_load_dwordx4 v3, s[32:35], 0 offen lds
    v_subrev_u32 v3, 25600, v2
    v_min_u32 v3, v3, v2
    s_add_u32 m0, s55, 9216
    v_add_u32 v2, 1024, v2
    buffer_load_dwordx4 v3, s[32:35], 0 offen lds
    v_subrev_u32 v3, 25600, v2
    v_min_u32 v3, v3, v2
    s_add_u32 m0, s55, 10240
    v_add_u32 v2, 1024, v2
    buffer_load_dwordx4 v3, s[32:35], 0 offen lds
    v_subrev_u32 v3, 25600, v2
    v_min_u32 v3, v3, v2
    s_add_u32 m0, s55, 11264
    v_add_u32 v2, 1024, v2
    buffer_load_dwordx4 v3, s[32:35], 0 offen lds
    v_subrev_u32 v3, 25600, v2
    v_min_u32 v3, v3, v2
    s_add_u32 m0, s55, 12288
    v_add_u32 v2, 1024, v2
    s_mov_b32 exec_hi, 0
    buffer_load_dwordx4 v3, s[32:35], 0 offen lds
    s_mov_b64 exec, -1
    s_mul_i32 s54, s60, 40960
    s_mul_i32 s52, s61, 20480
    s_add_u32 s54, s54, s52
    s_add_u32 s54, s54, 45056
    v_add_u32 v2, 0, v7
    v_xor_b32 v2, v2, v6
    v_lshlrev_b32 v2, 4, v2
    v_lshl_add_u32 v2, v7, 9, v2
    v_add_u32 v8, s54, v2
    v_add_u32 v2, 2, v7
    v_xor_b32 v2, v2, v6
    v_lshlrev_b32 v2, 4, v2
    v_lshl_add_u32 v2, v7, 9, v2
    v_add_u32 v9, s54, v2
    v_add_u32 v2, 4, v7
    v_xor_b32 v2, v2, v6
    v_lshlrev_b32 v2, 4, v2
    v_lshl_add_u32 v2, v7, 9, v2
    v_add_u32 v10, s54, v2
    v_add_u32 v2, 6, v7
    v_xor_b32 v2, v2, v6
    v_lshlrev_b32 v2, 4, v2
    v_lshl_add_u32 v2, v7, 9, v2
    v_add_u32 v11, s54, v2
    v_bfe_u32 v2, v1, 2, 2
    v_lshlrev_b32 v2, 1, v2
    v_lshl_add_u32 v2, v7, 3, v2
    v_bfe_u32 v3, v1, 4, 1
    v_and_b32 v5, 3, v1
    v_lshl_add_u32 v3, v3, 2, v5
    v_and_b32 v4, 1, v3
    v_lshlrev_b32 v4, 1, v4
    v_bfe_u32 v5, v3, 1, 1
    v_or_b32 v4, v4, v5
    v_and_b32 v3, 4, v3
    v_or_b32 v3, v3, v4
    v_cmp_lt_u32 vcc, 4, v3
    v_and_b32 v4, 1, v3
    v_lshlrev_b32 v4, 17, v4
    v_min_u32 v3, 4, v3
    v_cndmask_b32 v4, 0, v4, vcc
    v_add_u32 v3, v3, v4
    v_mul_u32_u24 v2, 40, v2
    v_lshl_add_u32 v2, v3, 3, v2
    v_add_u32 v19, s55, v2
    v_add_u32 v14, 150016, v22
    s_lshl_b32 s54, s48, 1
    s_add_u32 s54, s54, s60
    s_lshr_b32 s55, s54, 2
    s_mul_i32 s55, s55, 11264
    s_add_u32 s55, s55, 2621440
    s_and_b32 s54, s54, 3
    s_lshl_b32 s59, s60, 7
    s_add_u32 s59, s59, 162816
    v_and_b32 v2, 15, v1
    v_lshlrev_b32 v2, 3, v2
    v_lshrrev_b32 v3, 4, v1
    v_lshl_add_u32 v15, v3, 14, v2
    v_mov_b32 v5, 2147483648
    s_cmp_eq_u32 s15, 1
    s_cbranch_scc1 G_V
    v_lshlrev_b32 v23, 2, v6
    v_add_u32 v23, s59, v23
    v_lshlrev_b32 v17, 3, v6
    v_cmp_eq_u32 vcc, 0, v7
    v_mov_b32 v16, v22
    s_lshl_b32 s56, s54, 10
    v_cndmask_b32 v17, v5, v17, vcc
    s_add_u32 s56, s56, s55
    s_lshl_b32 s58, s54, 8
    s_add_u32 s58, s58, s55
    s_add_u32 s58, s58, 4096
    s_lshl_b32 s54, s48, 2
    s_and_b32 s52, s49, 3
    s_add_u32 s54, s54, s52
    s_lshl_b32 s54, s54, 7
    s_add_u32 s54, s54, 20971520
    s_waitcnt vmcnt(0)
    v_add_co_u32 v20, vcc, 0x7f4a7c14, v20
    v_mov_b32 v3, 0x9e3779b9
    s_nop 0
    v_addc_co_u32 v21, vcc, v21, v3, vcc
    s_nop 0
    v_readfirstlane_b32 s30, v20
    v_readfirstlane_b32 s31, v21
    ds_write_b64 v12, v[20:21] offset:256
    v_mov_b32 v3, 1
    ds_add_u32 v13, v3 offset:340
    s_mov_b32 s63, 1600000
LW_57:
    ds_read_b32 v2, v12 offset:336
    s_waitcnt lgkmcnt(0)
    v_readfirstlane_b32 s52, v2
    s_nop 1
    s_and_b32 s52, s52, 255
    s_cmp_ge_u32 s52, 4
    s_cbranch_scc1 LWD_58
    s_sleep 1
    s_sub_u32 s63, s63, 1
    s_cmp_lg_u32 s63, 0
    s_cbranch_scc1 LW_57
LWD_58:
    ds_read_b128 v[40:43], v8 offset:0
    ds_read_b64_tr_b16 v[44:45], v19 offset:0
    ds_read_b64_tr_b16 v[46:47], v19 offset:40
    ds_read_b128 v[48:51], v9 offset:1024
    ds_read_b64_tr_b16 v[52:53], v19 offset:640
    ds_read_b64_tr_b16 v[54:55], v19 offset:680
    ds_read_b128 v[56:59], v10 offset:2048
    ds_read_b64_tr_b16 v[60:61], v19 offset:1280
    ds_read_b64_tr_b16 v[62:63], v19 offset:1320
    ds_read_b128 v[64:67], v11 offset:3072
    ds_read_b64_tr_b16 v[68:69], v19 offset:1920
    ds_read_b64_tr_b16 v[70:71], v19 offset:1960
    s_waitcnt lgkmcnt(9)
    v_mfma_f32_32x32x16_bf16 v[24:39], v[44:47], v[40:43], 0
    ds_read_b128 v[40:43], v8 offset:4096
    ds_read_b64_tr_b16 v[44:45], v19 offset:2560
    ds_read_b64_tr_b16 v[46:47], v19 offset:2600
    s_waitcnt lgkmcnt(9)
    v_mfma_f32_32x32x16_bf16 v[24:39], v[52:55], v[48:51], v[24:39]
    ds_read_b128 v[48:51], v9 offset:5120
    ds_read_b64_tr_b16 v[52:53], v19 offset:3200
    ds_read_b64_tr_b16 v[54:55], v19 offset:3240
    s_waitcnt lgkmcnt(9)
    v_mfma_f32_32x32x16_bf16 v[24:39], v[60:63], v[56:59], v[24:39]
    ds_read_b128 v[56:59], v10 offset:6144
    ds_read_b64_tr_b16 v[60:61], v19 offset:3840
    ds_read_b64_tr_b16 v[62:63], v19 offset:3880
    s_waitcnt lgkmcnt(9)
    v_mfma_f32_32x32x16_bf16 v[24:39], v[68:71], v[64:67], v[24:39]
    ds_read_b128 v[64:67], v11 offset:7168
    ds_read_b64_tr_b16 v[68:69], v19 offset:4480
    ds_read_b64_tr_b16 v[70:71], v19 offset:4520
    s_waitcnt lgkmcnt(9)
    v_mfma_f32_32x32x16_bf16 v[24:39], v[44:47], v[40:43], v[24:39]
    ds_read_b128 v[40:43], v8 offset:8192
    ds_read_b64_tr_b16 v[44:45], v19 offset:5120
    ds_read_b64_tr_b16 v[46:47], v19 offset:5160
    s_waitcnt lgkmcnt(9)
    v_mfma_f32_32x32x16_bf16 v[24:39], v[52:55], v[48:51], v[24:39]
    ds_read_b128 v[48:51], v9 offset:9216
    ds_read_b64_tr_b16 v[52:53], v19 offset:5760
    ds_read_b64_tr_b16 v[54:55], v19 offset:5800
    s_waitcnt lgkmcnt(9)
    v_mfma_f32_32x32x16_bf16 v[24:39], v[60:63], v[56:59], v[24:39]
    ds_read_b128 v[56:59], v10 offset:10240
    ds_read_b64_tr_b16 v[60:61], v19 offset:6400
    ds_read_b64_tr_b16 v[62:63], v19 offset:6440
    s_waitcnt lgkmcnt(9)
    v_mfma_f32_32x32x16_bf16 v[24:39], v[68:71], v[64:67], v[24:39]
    ds_read_b128 v[64:67], v11 offset:11264
    ds_read_b64_tr_b16 v[68:69], v19 offset:7040
    ds_read_b64_tr_b16 v[70:71], v19 offset:7080
    s_waitcnt lgkmcnt(9)
    v_mfma_f32_32x32x16_bf16 v[24:39], v[44:47], v[40:43], v[24:39]
    ds_read_b128 v[40:43], v8 offset:12288
    ds_read_b64_tr_b16 v[44:45], v19 offset:7680
    ds_read_b64_tr_b16 v[46:47], v19 offset:7720
    s_waitcnt lgkmcnt(9)
    v_mfma_f32_32x32x16_bf16 v[24:39], v[52:55], v[48:51], v[24:39]
    ds_read_b128 v[48:51], v9 offset:13312
    ds_read_b64_tr_b16 v[52:53], v19 offset:8320
    ds_read_b64_tr_b16 v[54:55], v19 offset:8360
    s_waitcnt lgkmcnt(9)
    v_mfma_f32_32x32x16_bf16 v[24:39], v[60:63], v[56:59], v[24:39]
    ds_read_b128 v[56:59], v10 offset:14336
    ds_read_b64_tr_b16 v[60:61], v19 offset:8960
    ds_read_b64_tr_b16 v[62:63], v19 offset:9000
    s_waitcnt lgkmcnt(9)
    v_mfma_f32_32x32x16_bf16 v[24:39], v[68:71], v[64:67], v[24:39]
    ds_read_b128 v[64:67], v11 offset:15360
    ds_read_b64_tr_b16 v[68:69], v19 offset:9600
    ds_read_b64_tr_b16 v[70:71], v19 offset:9640
    s_waitcnt lgkmcnt(9)
    v_mfma_f32_32x32x16_bf16 v[24:39], v[44:47], v[40:43], v[24:39]
    ds_read_b128 v[40:43], v8 offset:16384
    ds_read_b64_tr_b16 v[44:45], v19 offset:10240
    ds_read_b64_tr_b16 v[46:47], v19 offset:10280
    s_waitcnt lgkmcnt(9)
    v_mfma_f32_32x32x16_bf16 v[24:39], v[52:55], v[48:51], v[24:39]
    ds_read_b128 v[48:51], v9 offset:17408
    ds_read_b64_tr_b16 v[52:53], v19 offset:10880
    ds_read_b64_tr_b16 v[54:55], v19 offset:10920
    s_waitcnt lgkmcnt(9)
    v_mfma_f32_32x32x16_bf16 v[24:39], v[60:63], v[56:59], v[24:39]
    ds_read_b128 v[56:59], v10 offset:18432
    ds_read_b64_tr_b16 v[60:61], v19 offset:11520
    ds_read_b64_tr_b16 v[62:63], v19 offset:11560
    s_waitcnt lgkmcnt(9)
    v_mfma_f32_32x32x16_bf16 v[24:39], v[68:71], v[64:67], v[24:39]
    ds_read_b128 v[64:67], v11 offset:19456
    ds_read_b64_tr_b16 v[68:69], v19 offset:12160
    ds_read_b64_tr_b16 v[70:71], v19 offset:12200
    s_waitcnt lgkmcnt(9)
    v_mfma_f32_32x32x16_bf16 v[24:39], v[44:47], v[40:43], v[24:39]
    s_waitcnt lgkmcnt(6)
    v_mfma_f32_32x32x16_bf16 v[24:39], v[52:55], v[48:51], v[24:39]
    s_waitcnt lgkmcnt(3)
    v_mfma_f32_32x32x16_bf16 v[24:39], v[60:63], v[56:59], v[24:39]
    s_waitcnt lgkmcnt(0)
    v_mfma_f32_32x32x16_bf16 v[24:39], v[68:71], v[64:67], v[24:39]
    s_cmp_eq_u32 s61, 1
    s_cbranch_scc1 G_KV9
    s_mov_b32 s63, 1600000
LW_59:
    ds_read_b32 v2, v12 offset:288
    s_waitcnt lgkmcnt(0)
    v_readfirstlane_b32 s52, v2
    s_nop 1
    s_cmp_ge_u32 s52, 1
    s_cbranch_scc1 LWD_60
    s_sleep 0
    s_sub_u32 s63, s63, 1
    s_cmp_lg_u32 s63, 0
    s_cbranch_scc1 LW_59
LWD_60:
    ds_read_b128 v[72:75], v14 offset:0
    ds_read_b128 v[76:79], v14 offset:1024
    ds_read_b128 v[80:83], v14 offset:2048
    ds_read_b32 v88, v23
    ds_add_u32 v13, v3 offset:288
    s_waitcnt lgkmcnt(0)
    v_add_f32 v24, v24, v72
    v_add_f32 v25, v25, v73
    v_add_f32 v26, v26, v74
    v_add_f32 v27, v27, v75
    v_add_f32 v28, v28, v76
    v_add_f32 v29, v29, v77
    v_add_f32 v30, v30, v78
    v_add_f32 v31, v31, v79
    v_add_f32 v32, v32, v80
    v_add_f32 v33, v33, v81
    v_add_f32 v34, v34, v82
    v_add_f32 v35, v35, v83
    v_mul_f32 v24, v88, v24
    v_mul_f32 v25, v88, v25
    v_mul_f32 v26, v88, v26
    v_mul_f32 v27, v88, v27
    v_mul_f32 v28, v88, v28
    v_mul_f32 v29, v88, v29
    v_mul_f32 v30, v88, v30
    v_mul_f32 v31, v88, v31
    v_mul_f32 v32, v88, v32
    v_mul_f32 v33, v88, v33
    v_mul_f32 v34, v88, v34
    v_mul_f32 v35, v88, v35
    v_cvt_pk_bf16_f32 v40, v24, v25
    v_cvt_pk_bf16_f32 v41, v26, v27
    v_cvt_pk_bf16_f32 v42, v28, v29
    v_cvt_pk_bf16_f32 v43, v30, v31
    v_cvt_pk_bf16_f32 v44, v32, v33
    v_cvt_pk_bf16_f32 v45, v34, v35
    buffer_store_dwordx4 v[40:43], v16, s[44:47], s56 offen sc1
    buffer_store_dwordx2 v[44:45], v17, s[44:47], s58 offen sc1
    s_branch G_KVEND
G_KV9:
    s_mov_b32 s63, 1600000
LW_61:
    ds_read_b32 v2, v12 offset:348
    s_waitcnt lgkmcnt(0)
    v_readfirstlane_b32 s52, v2
    s_nop 1
    s_and_b32 s52, s52, 255
    s_cmp_ge_u32 s52, 4
    s_cbranch_scc1 LWD_62
    s_sleep 0
    s_sub_u32 s63, s63, 1
    s_cmp_lg_u32 s63, 0
    s_cbranch_scc1 LW_61
LWD_62:
    s_nop 3
    ds_write_b128 v14, v[24:27] offset:0
    ds_write_b128 v14, v[28:31] offset:1024
    ds_write_b128 v14, v[32:35] offset:2048
    ds_write_b128 v14, v[36:39] offset:3072
    ds_add_u32 v13, v3 offset:288
    s_branch G_FFN1
G_V:
    v_lshlrev_b32 v23, 4, v7
    v_add_u32 v23, s59, v23
    v_mul_u32_u24 v16, 384, v7
    v_lshl_add_u32 v16, v6, 4, v16
    v_cmp_gt_u32 vcc, 24, v6
    s_mul_i32 s56, s54, 1536
    s_add_u32 s56, s56, s55
    v_cndmask_b32 v16, v5, v16, vcc
    s_add_u32 s56, s56, 5120
    s_add_u32 s58, s56, 768
    v_mov_b32 v17, v16
    v_cmp_eq_u32 vcc, 20, v6
    v_mov_b32 v18, 0x3f803f80
    s_nop 0
    v_cndmask_b32 v18, 0, v18, vcc
    s_lshl_b32 s54, s48, 2
    s_and_b32 s52, s49, 3
    s_add_u32 s54, s54, s52
    s_lshl_b32 s54, s54, 7
    s_add_u32 s54, s54, 20971520
    s_waitcnt vmcnt(0)
    v_add_co_u32 v20, vcc, 0x7f4a7c14, v20
    v_mov_b32 v3, 0x9e3779b9
    s_nop 0
    v_addc_co_u32 v21, vcc, v21, v3, vcc
    s_nop 0
    v_readfirstlane_b32 s30, v20
    v_readfirstlane_b32 s31, v21
    ds_write_b64 v12, v[20:21] offset:256
    v_mov_b32 v3, 1
    ds_add_u32 v13, v3 offset:340
    s_mov_b32 s63, 1600000
LW_63:
    ds_read_b32 v2, v12 offset:336
    s_waitcnt lgkmcnt(0)
    v_readfirstlane_b32 s52, v2
    s_nop 1
    s_and_b32 s52, s52, 255
    s_cmp_ge_u32 s52, 4
    s_cbranch_scc1 LWD_64
    s_sleep 1
    s_sub_u32 s63, s63, 1
    s_cmp_lg_u32 s63, 0
    s_cbranch_scc1 LW_63
LWD_64:
    ds_read_b128 v[40:43], v8 offset:0
    ds_read_b64_tr_b16 v[44:45], v19 offset:0
    ds_read_b64_tr_b16 v[46:47], v19 offset:40
    ds_read_b128 v[48:51], v9 offset:1024
    ds_read_b64_tr_b16 v[52:53], v19 offset:640
    ds_read_b64_tr_b16 v[54:55], v19 offset:680
    ds_read_b128 v[56:59], v10 offset:2048
    ds_read_b64_tr_b16 v[60:61], v19 offset:1280
    ds_read_b64_tr_b16 v[62:63], v19 offset:1320
    ds_read_b128 v[64:67], v11 offset:3072
    ds_read_b64_tr_b16 v[68:69], v19 offset:1920
    ds_read_b64_tr_b16 v[70:71], v19 offset:1960
    s_waitcnt lgkmcnt(9)
    v_mfma_f32_32x32x16_bf16 v[24:39], v[40:43], v[44:47], 0
    ds_read_b128 v[40:43], v8 offset:4096
    ds_read_b64_tr_b16 v[44:45], v19 offset:2560
    ds_read_b64_tr_b16 v[46:47], v19 offset:2600
    s_waitcnt lgkmcnt(9)
    v_mfma_f32_32x32x16_bf16 v[24:39], v[48:51], v[52:55], v[24:39]
    ds_read_b128 v[48:51], v9 offset:5120
    ds_read_b64_tr_b16 v[52:53], v19 offset:3200
    ds_read_b64_tr_b16 v[54:55], v19 offset:3240
    s_waitcnt lgkmcnt(9)
    v_mfma_f32_32x32x16_bf16 v[24:39], v[56:59], v[60:63], v[24:39]
    ds_read_b128 v[56:59], v10 offset:6144
    ds_read_b64_tr_b16 v[60:61], v19 offset:3840
    ds_read_b64_tr_b16 v[62:63], v19 offset:3880
    s_waitcnt lgkmcnt(9)
    v_mfma_f32_32x32x16_bf16 v[24:39], v[64:67], v[68:71], v[24:39]
    ds_read_b128 v[64:67], v11 offset:7168
    ds_read_b64_tr_b16 v[68:69], v19 offset:4480
    ds_read_b64_tr_b16 v[70:71], v19 offset:4520
    s_waitcnt lgkmcnt(9)
    v_mfma_f32_32x32x16_bf16 v[24:39], v[40:43], v[44:47], v[24:39]
    ds_read_b128 v[40:43], v8 offset:8192
    ds_read_b64_tr_b16 v[44:45], v19 offset:5120
    ds_read_b64_tr_b16 v[46:47], v19 offset:5160
    s_waitcnt lgkmcnt(9)
    v_mfma_f32_32x32x16_bf16 v[24:39], v[48:51], v[52:55], v[24:39]
    ds_read_b128 v[48:51], v9 offset:9216
    ds_read_b64_tr_b16 v[52:53], v19 offset:5760
    ds_read_b64_tr_b16 v[54:55], v19 offset:5800
    s_waitcnt lgkmcnt(9)
    v_mfma_f32_32x32x16_bf16 v[24:39], v[56:59], v[60:63], v[24:39]
    ds_read_b128 v[56:59], v10 offset:10240
    ds_read_b64_tr_b16 v[60:61], v19 offset:6400
    ds_read_b64_tr_b16 v[62:63], v19 offset:6440
    s_waitcnt lgkmcnt(9)
    v_mfma_f32_32x32x16_bf16 v[24:39], v[64:67], v[68:71], v[24:39]
    ds_read_b128 v[64:67], v11 offset:11264
    ds_read_b64_tr_b16 v[68:69], v19 offset:7040
    ds_read_b64_tr_b16 v[70:71], v19 offset:7080
    s_waitcnt lgkmcnt(9)
    v_mfma_f32_32x32x16_bf16 v[24:39], v[40:43], v[44:47], v[24:39]
    ds_read_b128 v[40:43], v8 offset:12288
    ds_read_b64_tr_b16 v[44:45], v19 offset:7680
    ds_read_b64_tr_b16 v[46:47], v19 offset:7720
    s_waitcnt lgkmcnt(9)
    v_mfma_f32_32x32x16_bf16 v[24:39], v[48:51], v[52:55], v[24:39]
    ds_read_b128 v[48:51], v9 offset:13312
    ds_read_b64_tr_b16 v[52:53], v19 offset:8320
    ds_read_b64_tr_b16 v[54:55], v19 offset:8360
    s_waitcnt lgkmcnt(9)
    v_mfma_f32_32x32x16_bf16 v[24:39], v[56:59], v[60:63], v[24:39]
    ds_read_b128 v[56:59], v10 offset:14336
    ds_read_b64_tr_b16 v[60:61], v19 offset:8960
    ds_read_b64_tr_b16 v[62:63], v19 offset:9000
    s_waitcnt lgkmcnt(9)
    v_mfma_f32_32x32x16_bf16 v[24:39], v[64:67], v[68:71], v[24:39]
    ds_read_b128 v[64:67], v11 offset:15360
    ds_read_b64_tr_b16 v[68:69], v19 offset:9600
    ds_read_b64_tr_b16 v[70:71], v19 offset:9640
    s_waitcnt lgkmcnt(9)
    v_mfma_f32_32x32x16_bf16 v[24:39], v[40:43], v[44:47], v[24:39]
    ds_read_b128 v[40:43], v8 offset:16384
    ds_read_b64_tr_b16 v[44:45], v19 offset:10240
    ds_read_b64_tr_b16 v[46:47], v19 offset:10280
    s_waitcnt lgkmcnt(9)
    v_mfma_f32_32x32x16_bf16 v[24:39], v[48:51], v[52:55], v[24:39]
    ds_read_b128 v[48:51], v9 offset:17408
    ds_read_b64_tr_b16 v[52:53], v19 offset:10880
    ds_read_b64_tr_b16 v[54:55], v19 offset:10920
    s_waitcnt lgkmcnt(9)
    v_mfma_f32_32x32x16_bf16 v[24:39], v[56:59], v[60:63], v[24:39]
    ds_read_b128 v[56:59], v10 offset:18432
    ds_read_b64_tr_b16 v[60:61], v19 offset:11520
    ds_read_b64_tr_b16 v[62:63], v19 offset:11560
    s_waitcnt lgkmcnt(9)
    v_mfma_f32_32x32x16_bf16 v[24:39], v[64:67], v[68:71], v[24:39]
    ds_read_b128 v[64:67], v11 offset:19456
    ds_read_b64_tr_b16 v[68:69], v19 offset:12160
    ds_read_b64_tr_b16 v[70:71], v19 offset:12200
    s_waitcnt lgkmcnt(9)
    v_mfma_f32_32x32x16_bf16 v[24:39], v[40:43], v[44:47], v[24:39]
    s_waitcnt lgkmcnt(6)
    v_mfma_f32_32x32x16_bf16 v[24:39], v[48:51], v[52:55], v[24:39]
    s_waitcnt lgkmcnt(3)
    v_mfma_f32_32x32x16_bf16 v[24:39], v[56:59], v[60:63], v[24:39]
    s_waitcnt lgkmcnt(0)
    v_mfma_f32_32x32x16_bf16 v[24:39], v[64:67], v[68:71], v[24:39]
    s_cmp_eq_u32 s61, 1
    s_cbranch_scc1 G_KV9
    s_mov_b32 s63, 1600000
LW_65:
    ds_read_b32 v2, v12 offset:288
    s_waitcnt lgkmcnt(0)
    v_readfirstlane_b32 s52, v2
    s_nop 1
    s_cmp_ge_u32 s52, 1
    s_cbranch_scc1 LWD_66
    s_sleep 0
    s_sub_u32 s63, s63, 1
    s_cmp_lg_u32 s63, 0
    s_cbranch_scc1 LW_65
LWD_66:
    ds_read_b128 v[72:75], v14 offset:0
    ds_read_b128 v[76:79], v14 offset:1024
    ds_read_b128 v[80:83], v14 offset:2048
    ds_read_b128 v[84:87], v14 offset:3072
    ds_read_b128 v[88:91], v23 offset:0
    ds_read_b128 v[92:95], v23 offset:32
    ds_read_b128 v[96:99], v23 offset:64
    ds_read_b128 v[100:103], v23 offset:96
    ds_add_u32 v13, v3 offset:288
    s_waitcnt lgkmcnt(0)
    v_add_f32 v24, v24, v72
    v_add_f32 v25, v25, v73
    v_add_f32 v26, v26, v74
    v_add_f32 v27, v27, v75
    v_add_f32 v28, v28, v76
    v_add_f32 v29, v29, v77
    v_add_f32 v30, v30, v78
    v_add_f32 v31, v31, v79
    v_add_f32 v32, v32, v80
    v_add_f32 v33, v33, v81
    v_add_f32 v34, v34, v82
    v_add_f32 v35, v35, v83
    v_add_f32 v36, v36, v84
    v_add_f32 v37, v37, v85
    v_add_f32 v38, v38, v86
    v_add_f32 v39, v39, v87
    v_mul_f32 v24, v88, v24
    v_mul_f32 v25, v89, v25
    v_mul_f32 v26, v90, v26
    v_mul_f32 v27, v91, v27
    v_mul_f32 v28, v92, v28
    v_mul_f32 v29, v93, v29
    v_mul_f32 v30, v94, v30
    v_mul_f32 v31, v95, v31
    v_mul_f32 v32, v96, v32
    v_mul_f32 v33, v97, v33
    v_mul_f32 v34, v98, v34
    v_mul_f32 v35, v99, v35
    v_mul_f32 v36, v100, v36
    v_mul_f32 v37, v101, v37
    v_mul_f32 v38, v102, v38
    v_mul_f32 v39, v103, v39
    v_cvt_pk_bf16_f32 v40, v24, v25
    v_cvt_pk_bf16_f32 v41, v26, v27
    v_cvt_pk_bf16_f32 v42, v28, v29
    v_cvt_pk_bf16_f32 v43, v30, v31
    v_cvt_pk_bf16_f32 v44, v32, v33
    v_cvt_pk_bf16_f32 v45, v34, v35
    v_cvt_pk_bf16_f32 v46, v36, v37
    v_cvt_pk_bf16_f32 v47, v38, v39
    v_cmp_gt_u32 vcc, 20, v6
    s_nop 1
    v_cndmask_b32 v40, v18, v40, vcc
    v_cndmask_b32 v41, v18, v41, vcc
    v_cndmask_b32 v42, v18, v42, vcc
    v_cndmask_b32 v43, v18, v43, vcc
    v_cndmask_b32 v44, v18, v44, vcc
    v_cndmask_b32 v45, v18, v45, vcc
    v_cndmask_b32 v46, v18, v46, vcc
    v_cndmask_b32 v47, v18, v47, vcc
    buffer_store_dwordx4 v[40:43], v16, s[44:47], s56 offen sc1
    buffer_store_dwordx4 v[44:47], v17, s[44:47], s58 offen sc1
G_KVEND:
    s_waitcnt vmcnt(0)
    s_mov_b32 exec_hi, 0
    buffer_store_dwordx2 v[20:21], v15, s[44:47], s54 offen sc1
    s_mov_b64 exec, -1
    buffer_load_dword v49, v16, s[44:47], s56 offen sc1
    buffer_load_dword v50, v17, s[44:47], s58 offen sc1
    s_branch G_FFN1
G_LOAD:
    s_mov_b32 s32, s6
    s_mov_b32 s33, s7
    s_mov_b32 s34, 819200
    s_mov_b32 s35, 0x20000
    s_sub_u32 s54, s50, 10
    s_mul_i32 s55, s54, 5120
    s_mul_i32 s54, s54, 320
    s_mul_i32 s52, s49, 160
    v_add_u32 v2, 0, v1
    v_add_u32 v2, s54, v2
    v_mul_u32_u24 v3, 6554, v2
    v_lshrrev_b32 v3, 16, v3
    v_mul_u32_u24 v4, 10, v3
    v_sub_u32 v4, v2, v4
    v_mul_u32_u24 v3, 1280, v3
    v_lshl_add_u32 v3, v4, 4, v3
    v_add_u32 v14, s52, v3
    v_add_u32 v2, 64, v1
    v_add_u32 v2, s54, v2
    v_mul_u32_u24 v3, 6554, v2
    v_lshrrev_b32 v3, 16, v3
    v_mul_u32_u24 v4, 10, v3
    v_sub_u32 v4, v2, v4
    v_mul_u32_u24 v3, 1280, v3
    v_lshl_add_u32 v3, v4, 4, v3
    v_add_u32 v15, s52, v3
    v_add_u32 v2, 128, v1
    v_add_u32 v2, s54, v2
    v_mul_u32_u24 v3, 6554, v2
    v_lshrrev_b32 v3, 16, v3
    v_mul_u32_u24 v4, 10, v3
    v_sub_u32 v4, v2, v4
    v_mul_u32_u24 v3, 1280, v3
    v_lshl_add_u32 v3, v4, 4, v3
    v_add_u32 v16, s52, v3
    v_add_u32 v2, 192, v1
    v_add_u32 v2, s54, v2
    v_mul_u32_u24 v3, 6554, v2
    v_lshrrev_b32 v3, 16, v3
    v_mul_u32_u24 v4, 10, v3
    v_sub_u32 v4, v2, v4
    v_mul_u32_u24 v3, 1280, v3
    v_lshl_add_u32 v3, v4, 4, v3
    v_add_u32 v17, s52, v3
    v_add_u32 v2, 256, v1
    v_add_u32 v2, s54, v2
    v_mul_u32_u24 v3, 6554, v2
    v_lshrrev_b32 v3, 16, v3
    v_mul_u32_u24 v4, 10, v3
    v_sub_u32 v4, v2, v4
    v_mul_u32_u24 v3, 1280, v3
    v_lshl_add_u32 v3, v4, 4, v3
    v_add_u32 v18, s52, v3
    s_mov_b32 s56, s62
    v_mov_b32 v19, 1
    s_mov_b32 s63, 1600000
LW_67:
    ds_read_b32 v2, v12 offset:344
    s_waitcnt lgkmcnt(0)
    v_readfirstlane_b32 s52, v2
    s_nop 1
    s_cmp_ge_u32 s52, 8
    s_cbranch_scc1 LWD_68
    s_sleep 1
    s_sub_u32 s63, s63, 1
    s_cmp_lg_u32 s63, 0
    s_cbranch_scc1 LW_67
LWD_68:
    s_mul_i32 s57, s56, 81920
    s_add_u32 m0, s55, 0
    s_nop 0
    buffer_load_dwordx4 v14, s[32:35], s57 offen lds
    s_add_u32 m0, s55, 1024
    s_nop 0
    buffer_load_dwordx4 v15, s[32:35], s57 offen lds
    s_add_u32 m0, s55, 2048
    s_nop 0
    buffer_load_dwordx4 v16, s[32:35], s57 offen lds
    s_add_u32 m0, s55, 3072
    s_nop 0
    buffer_load_dwordx4 v17, s[32:35], s57 offen lds
    s_add_u32 m0, s55, 4096
    s_nop 0
    buffer_load_dwordx4 v18, s[32:35], s57 offen lds
    s_add_u32 s56, s56, 1
    s_cmp_eq_u32 s56, 10
    s_cselect_b32 s56, 0, s56
    s_mul_i32 s57, s56, 81920
    s_add_u32 m0, s55, 11264
    s_nop 0
    buffer_load_dwordx4 v14, s[32:35], s57 offen lds
    s_add_u32 m0, s55, 12288
    s_nop 0
    buffer_load_dwordx4 v15, s[32:35], s57 offen lds
    s_add_u32 m0, s55, 13312
    s_nop 0
    buffer_load_dwordx4 v16, s[32:35], s57 offen lds
    s_add_u32 m0, s55, 14336
    s_nop 0
    buffer_load_dwordx4 v17, s[32:35], s57 offen lds
    s_add_u32 m0, s55, 15360
    s_nop 0
    buffer_load_dwordx4 v18, s[32:35], s57 offen lds
    s_add_u32 s56, s56, 1
    s_cmp_eq_u32 s56, 10
    s_cselect_b32 s56, 0, s56
    s_mul_i32 s57, s56, 81920
    s_add_u32 m0, s55, 22528
    s_nop 0
    buffer_load_dwordx4 v14, s[32:35], s57 offen lds
    s_add_u32 m0, s55, 23552
    s_nop 0
    buffer_load_dwordx4 v15, s[32:35], s57 offen lds
    s_add_u32 m0, s55, 24576
    s_nop 0
    buffer_load_dwordx4 v16, s[32:35], s57 offen lds
    s_add_u32 m0, s55, 25600
    s_nop 0
    buffer_load_dwordx4 v17, s[32:35], s57 offen lds
    s_add_u32 m0, s55, 26624
    s_nop 0
    buffer_load_dwordx4 v18, s[32:35], s57 offen lds
    s_add_u32 s56, s56, 1
    s_cmp_eq_u32 s56, 10
    s_cselect_b32 s56, 0, s56
    s_mul_i32 s57, s56, 81920
    s_add_u32 m0, s55, 33792
    s_nop 0
    buffer_load_dwordx4 v14, s[32:35], s57 offen lds
    s_add_u32 m0, s55, 34816
    s_nop 0
    buffer_load_dwordx4 v15, s[32:35], s57 offen lds
    s_add_u32 m0, s55, 35840
    s_nop 0
    buffer_load_dwordx4 v16, s[32:35], s57 offen lds
    s_add_u32 m0, s55, 36864
    s_nop 0
    buffer_load_dwordx4 v17, s[32:35], s57 offen lds
    s_add_u32 m0, s55, 37888
    s_nop 0
    buffer_load_dwordx4 v18, s[32:35], s57 offen lds
    s_add_u32 s56, s56, 1
    s_cmp_eq_u32 s56, 10
    s_cselect_b32 s56, 0, s56
    s_waitcnt vmcnt(10)
    ds_add_u32 v13, v19 offset:292
    s_mul_i32 s57, s56, 81920
    s_add_u32 m0, s55, 126976
    s_nop 0
    buffer_load_dwordx4 v14, s[32:35], s57 offen lds
    s_add_u32 m0, s55, 128000
    s_nop 0
    buffer_load_dwordx4 v15, s[32:35], s57 offen lds
    s_add_u32 m0, s55, 129024
    s_nop 0
    buffer_load_dwordx4 v16, s[32:35], s57 offen lds
    s_add_u32 m0, s55, 130048
    s_nop 0
    buffer_load_dwordx4 v17, s[32:35], s57 offen lds
    s_add_u32 m0, s55, 131072
    s_nop 0
    buffer_load_dwordx4 v18, s[32:35], s57 offen lds
    s_add_u32 s56, s56, 1
    s_cmp_eq_u32 s56, 10
    s_cselect_b32 s56, 0, s56
    s_mul_i32 s57, s56, 81920
    buffer_load_dwordx4 v[24:27], v14, s[32:35], s57 offen
    buffer_load_dwordx4 v[28:31], v15, s[32:35], s57 offen
    buffer_load_dwordx4 v[32:35], v16, s[32:35], s57 offen
    buffer_load_dwordx4 v[36:39], v17, s[32:35], s57 offen
    buffer_load_dwordx4 v[40:43], v18, s[32:35], s57 offen
    s_add_u32 s57, s55, 137216
    v_add_u32 v20, s57, v22
    s_waitcnt vmcnt(10)
    ds_add_u32 v13, v19 offset:296
    s_mov_b32 s63, 1600000
LW_69:
    ds_read_b32 v2, v12 offset:288
    s_waitcnt lgkmcnt(0)
    v_readfirstlane_b32 s52, v2
    s_nop 1
    s_cmp_ge_u32 s52, 2
    s_cbranch_scc1 LWD_70
    s_sleep 1
    s_sub_u32 s63, s63, 1
    s_cmp_lg_u32 s63, 0
    s_cbranch_scc1 LW_69
LWD_70:
    s_waitcnt vmcnt(0)
    ds_write_b128 v20, v[24:27] offset:0
    ds_write_b128 v20, v[28:31] offset:1024
    ds_write_b128 v20, v[32:35] offset:2048
    ds_write_b128 v20, v[36:39] offset:3072
    ds_write_b128 v20, v[40:43] offset:4096
    ds_add_u32 v13, v19 offset:300
    s_setprio 2
    s_mov_b32 s63, 1600000
LW_71:
    ds_read_b32 v2, v12 offset:340
    s_waitcnt lgkmcnt(0)
    v_readfirstlane_b32 s52, v2
    s_nop 1
    s_cmp_ge_u32 s52, 2
    s_cbranch_scc1 LWD_72
    s_sleep 0
    s_sub_u32 s63, s63, 1
    s_cmp_lg_u32 s63, 0
    s_cbranch_scc1 LW_71
LWD_72:
    ds_read_b64 v[2:3], v12 offset:256
    s_waitcnt lgkmcnt(0)
    v_readfirstlane_b32 s30, v2
    v_readfirstlane_b32 s31, v3
G_FFN1:
    s_setprio 2
    s_mul_i32 s54, s49, 3
    s_add_u32 s52, s49, 1
    s_lshr_b32 s52, s52, 1
    s_min_u32 s52, s52, 3
    s_add_u32 s54, s54, s52
    s_add_u32 s54, s54, s61
    s_lshl_b32 s58, s61, 7
    s_lshl_b32 s52, s48, 12
    s_add_u32 s58, s58, s52
    s_lshl_b32 s52, s49, 9
    s_add_u32 s58, s58, s52
    s_add_u32 s58, s58, 21102592
    s_cmp_lt_u32 s61, 3
    s_cbranch_scc1 G_F1GO
    s_lshl_b32 s59, s2, 7
    s_add_u32 s59, s59, 21037056
    s_lshr_b32 s52, 0x15, s49
    s_bitcmp1_b32 s52, 0
    s_cbranch_scc0 G_RP
    v_mov_b32 v2, s30
    v_mov_b32 v3, s31
    v_lshlrev_b32 v4, 3, v1
    s_mov_b64 exec, 0xffff
    buffer_store_dwordx2 v[2:3], v4, s[44:47], s59 offen sc1
    s_mov_b64 exec, -1
    s_branch G_F1GO
G_RP:
    v_mov_b32 v2, s30
    v_mov_b32 v3, s31
    v_lshlrev_b32 v4, 3, v1
    s_mov_b64 exec, 0xffff
    buffer_store_dwordx2 v[2:3], v4, s[44:47], s58 offen sc1
    s_mov_b64 exec, -1
    s_mov_b32 s63, 1600000
LW_73:
    ds_read_b32 v2, v12 offset:272
    s_waitcnt lgkmcnt(0)
    v_readfirstlane_b32 s52, v2
    s_nop 1
    s_cmp_ge_u32 s52, 2008
    s_cbranch_scc1 LWD_74
    s_sleep 8
    s_sub_u32 s63, s63, 1
    s_cmp_lg_u32 s63, 0
    s_cbranch_scc1 LW_73
LWD_74:
    s_lshr_b32 s52, s49, 1
    s_cmp_eq_u32 s49, 7
    s_addc_u32 s52, s52, 0
    s_mul_i32 s53, s48, 5
    s_add_u32 s56, s52, s53
    s_cmp_ge_u32 s56, 148
    s_cbranch_scc1 G_RPD
    s_cmp_lt_u32 s56, 108
    s_cselect_b32 s32, s20, s12
    s_cselect_b32 s33, s21, s13
    s_mov_b32 s34, 819200
    s_cmov_b32 s34, 2211840
    s_mov_b32 s35, 0x20000
    s_cselect_b32 s57, 0, 108
    s_sub_u32 s57, s56, s57
    s_mul_i32 s57, s57, 20480
    buffer_load_dwordx4 v[24:27], v22, s[32:35], s57 offen offset:0
    buffer_load_dwordx4 v[28:31], v22, s[32:35], s57 offen offset:1024
    buffer_load_dwordx4 v[32:35], v22, s[32:35], s57 offen offset:2048
    buffer_load_dwordx4 v[36:39], v22, s[32:35], s57 offen offset:3072
    s_add_u32 s57, s57, 4096
    buffer_load_dwordx4 v[40:43], v22, s[32:35], s57 offen offset:0
    buffer_load_dwordx4 v[44:47], v22, s[32:35], s57 offen offset:1024
    buffer_load_dwordx4 v[48:51], v22, s[32:35], s57 offen offset:2048
    buffer_load_dwordx4 v[52:55], v22, s[32:35], s57 offen offset:3072
    s_add_u32 s57, s57, 4096
    buffer_load_dwordx4 v[56:59], v22, s[32:35], s57 offen offset:0
    buffer_load_dwordx4 v[60:63], v22, s[32:35], s57 offen offset:1024
    buffer_load_dwordx4 v[64:67], v22, s[32:35], s57 offen offset:2048
    buffer_load_dwordx4 v[68:71], v22, s[32:35], s57 offen offset:3072
    s_add_u32 s57, s57, 4096
    buffer_load_dwordx4 v[72:75], v22, s[32:35], s57 offen offset:0
    buffer_load_dwordx4 v[76:79], v22, s[32:35], s57 offen offset:1024
    buffer_load_dwordx4 v[80:83], v22, s[32:35], s57 offen offset:2048
    buffer_load_dwordx4 v[84:87], v22, s[32:35], s57 offen offset:3072
    s_add_u32 s57, s57, 4096
    buffer_load_dwordx4 v[88:91], v22, s[32:35], s57 offen offset:0
    buffer_load_dwordx4 v[92:95], v22, s[32:35], s57 offen offset:1024
    buffer_load_dwordx4 v[96:99], v22, s[32:35], s57 offen offset:2048
    buffer_load_dwordx4 v[100:103], v22, s[32:35], s57 offen offset:3072
    s_mov_b32 s60, 378880
    v_add_u32 v2, 0, v1
    v_mul_u32_u24 v3, 6554, v2
    v_lshrrev_b32 v3, 16, v3
    v_mul_u32_u24 v4, 10, v3
    v_sub_u32 v2, v2, v4
    v_and_b32 v4, 7, v3
    v_lshrrev_b32 v3, 3, v3
    v_mul_u32_u24 v3, 320, v3
    v_mad_u32_u24 v3, v4, s60, v3
    v_lshl_add_u32 v14, v2, 4, v3
    v_add_u32 v2, 64, v1
    v_mul_u32_u24 v3, 6554, v2
    v_lshrrev_b32 v3, 16, v3
    v_mul_u32_u24 v4, 10, v3
    v_sub_u32 v2, v2, v4
    v_and_b32 v4, 7, v3
    v_lshrrev_b32 v3, 3, v3
    v_mul_u32_u24 v3, 320, v3
    v_mad_u32_u24 v3, v4, s60, v3
    v_lshl_add_u32 v15, v2, 4, v3
    v_add_u32 v2, 128, v1
    v_mul_u32_u24 v3, 6554, v2
    v_lshrrev_b32 v3, 16, v3
    v_mul_u32_u24 v4, 10, v3
    v_sub_u32 v2, v2, v4
    v_and_b32 v4, 7, v3
    v_lshrrev_b32 v3, 3, v3
    v_mul_u32_u24 v3, 320, v3
    v_mad_u32_u24 v3, v4, s60, v3
    v_lshl_add_u32 v16, v2, 4, v3
    v_add_u32 v2, 192, v1
    v_mul_u32_u24 v3, 6554, v2
    v_lshrrev_b32 v3, 16, v3
    v_mul_u32_u24 v4, 10, v3
    v_sub_u32 v2, v2, v4
    v_and_b32 v4, 7, v3
    v_lshrrev_b32 v3, 3, v3
    v_mul_u32_u24 v3, 320, v3
    v_mad_u32_u24 v3, v4, s60, v3
    v_lshl_add_u32 v17, v2, 4, v3
    v_add_u32 v2, 256, v1
    v_mul_u32_u24 v3, 6554, v2
    v_lshrrev_b32 v3, 16, v3
    v_mul_u32_u24 v4, 10, v3
    v_sub_u32 v2, v2, v4
    v_and_b32 v4, 7, v3
    v_lshrrev_b32 v3, 3, v3
    v_mul_u32_u24 v3, 320, v3
    v_mad_u32_u24 v3, v4, s60, v3
    v_lshl_add_u32 v18, v2, 4, v3
    s_lshl_b32 s57, s56, 2
    s_add_u32 s57, s57, 0
    s_sub_u32 s52, s57, 432
    s_mul_i32 s53, s52, 205
    s_lshr_b32 s53, s53, 10
    s_mul_i32 s60, s53, 5
    s_sub_u32 s52, s52, s60
    s_and_b32 s60, s53, 3
    s_lshr_b32 s53, s53, 2
    s_mul_i32 s53, s53, 20
    s_add_u32 s53, s53, 432
    s_lshl_b32 s54, s60, 2
    s_add_u32 s54, s54, s52
    s_add_u32 s60, s60, 16
    s_cmp_lt_u32 s52, 4
    s_cselect_b32 s60, s54, s60
    s_add_u32 s53, s53, s60
    s_cmp_lt_u32 s56, 108
    s_cselect_b32 s57, s57, s53
    s_and_b32 s52, s57, 1
    s_mul_i32 s52, s52, 480
    s_mul_i32 s57, s57, 640
    s_sub_u32 s57, s57, s52
    s_add_u32 s57, s57, 10485760
    s_waitcnt vmcnt(19)
    buffer_store_dwordx4 v[24:27], v14, s[44:47], s57 offen sc1
    s_waitcnt vmcnt(19)
    buffer_store_dwordx4 v[28:31], v15, s[44:47], s57 offen sc1
    s_waitcnt vmcnt(19)
    buffer_store_dwordx4 v[32:35], v16, s[44:47], s57 offen sc1
    s_waitcnt vmcnt(19)
    buffer_store_dwordx4 v[36:39], v17, s[44:47], s57 offen sc1
    s_waitcnt vmcnt(19)
    buffer_store_dwordx4 v[40:43], v18, s[44:47], s57 offen sc1
    s_lshl_b32 s57, s56, 2
    s_add_u32 s57, s57, 1
    s_sub_u32 s52, s57, 432
    s_mul_i32 s53, s52, 205
    s_lshr_b32 s53, s53, 10
    s_mul_i32 s60, s53, 5
    s_sub_u32 s52, s52, s60
    s_and_b32 s60, s53, 3
    s_lshr_b32 s53, s53, 2
    s_mul_i32 s53, s53, 20
    s_add_u32 s53, s53, 432
    s_lshl_b32 s54, s60, 2
    s_add_u32 s54, s54, s52
    s_add_u32 s60, s60, 16
    s_cmp_lt_u32 s52, 4
    s_cselect_b32 s60, s54, s60
    s_add_u32 s53, s53, s60
    s_cmp_lt_u32 s56, 108
    s_cselect_b32 s57, s57, s53
    s_and_b32 s52, s57, 1
    s_mul_i32 s52, s52, 480
    s_mul_i32 s57, s57, 640
    s_sub_u32 s57, s57, s52
    s_add_u32 s57, s57, 10485760
    s_waitcnt vmcnt(19)
    buffer_store_dwordx4 v[44:47], v14, s[44:47], s57 offen sc1
    s_waitcnt vmcnt(19)
    buffer_store_dwordx4 v[48:51], v15, s[44:47], s57 offen sc1
    s_waitcnt vmcnt(19)
    buffer_store_dwordx4 v[52:55], v16, s[44:47], s57 offen sc1
    s_waitcnt vmcnt(19)
    buffer_store_dwordx4 v[56:59], v17, s[44:47], s57 offen sc1
    s_waitcnt vmcnt(19)
    buffer_store_dwordx4 v[60:63], v18, s[44:47], s57 offen sc1
    s_lshl_b32 s57, s56, 2
    s_add_u32 s57, s57, 2
    s_sub_u32 s52, s57, 432
    s_mul_i32 s53, s52, 205
    s_lshr_b32 s53, s53, 10
    s_mul_i32 s60, s53, 5
    s_sub_u32 s52, s52, s60
    s_and_b32 s60, s53, 3
    s_lshr_b32 s53, s53, 2
    s_mul_i32 s53, s53, 20
    s_add_u32 s53, s53, 432
    s_lshl_b32 s54, s60, 2
    s_add_u32 s54, s54, s52
    s_add_u32 s60, s60, 16
    s_cmp_lt_u32 s52, 4
    s_cselect_b32 s60, s54, s60
    s_add_u32 s53, s53, s60
    s_cmp_lt_u32 s56, 108
    s_cselect_b32 s57, s57, s53
    s_and_b32 s52, s57, 1
    s_mul_i32 s52, s52, 480
    s_mul_i32 s57, s57, 640
    s_sub_u32 s57, s57, s52
    s_add_u32 s57, s57, 10485760
    s_waitcnt vmcnt(19)
    buffer_store_dwordx4 v[64:67], v14, s[44:47], s57 offen sc1
    s_waitcnt vmcnt(19)
    buffer_store_dwordx4 v[68:71], v15, s[44:47], s57 offen sc1
    s_waitcnt vmcnt(19)
    buffer_store_dwordx4 v[72:75], v16, s[44:47], s57 offen sc1
    s_waitcnt vmcnt(19)
    buffer_store_dwordx4 v[76:79], v17, s[44:47], s57 offen sc1
    s_waitcnt vmcnt(19)
    buffer_store_dwordx4 v[80:83], v18, s[44:47], s57 offen sc1
    s_lshl_b32 s57, s56, 2
    s_add_u32 s57, s57, 3
    s_sub_u32 s52, s57, 432
    s_mul_i32 s53, s52, 205
    s_lshr_b32 s53, s53, 10
    s_mul_i32 s60, s53, 5
    s_sub_u32 s52, s52, s60
    s_and_b32 s60, s53, 3
    s_lshr_b32 s53, s53, 2
    s_mul_i32 s53, s53, 20
    s_add_u32 s53, s53, 432
    s_lshl_b32 s54, s60, 2
    s_add_u32 s54, s54, s52
    s_add_u32 s60, s60, 16
    s_cmp_lt_u32 s52, 4
    s_cselect_b32 s60, s54, s60
    s_add_u32 s53, s53, s60
    s_cmp_lt_u32 s56, 108
    s_cselect_b32 s57, s57, s53
    s_and_b32 s52, s57, 1
    s_mul_i32 s52, s52, 480
    s_mul_i32 s57, s57, 640
    s_sub_u32 s57, s57, s52
    s_add_u32 s57, s57, 10485760
    s_waitcnt vmcnt(19)
    buffer_store_dwordx4 v[84:87], v14, s[44:47], s57 offen sc1
    s_waitcnt vmcnt(19)
    buffer_store_dwordx4 v[88:91], v15, s[44:47], s57 offen sc1
    s_waitcnt vmcnt(19)
    buffer_store_dwordx4 v[92:95], v16, s[44:47], s57 offen sc1
    s_waitcnt vmcnt(19)
    buffer_store_dwordx4 v[96:99], v17, s[44:47], s57 offen sc1
    s_waitcnt vmcnt(19)
    buffer_store_dwordx4 v[100:103], v18, s[44:47], s57 offen sc1
G_RPD:
    s_waitcnt vmcnt(0)
    v_mov_b32 v2, s30
    v_mov_b32 v3, s31
    v_lshlrev_b32 v4, 3, v1
    s_mov_b64 exec, 0xffff
    buffer_store_dwordx2 v[2:3], v4, s[44:47], s59 offen sc1
    s_mov_b64 exec, -1
    s_mov_b32 s63, 1600000
LW_75:
    ds_read_b32 v2, v12 offset:280
    s_waitcnt lgkmcnt(0)
    v_readfirstlane_b32 s52, v2
    s_nop 1
    s_cmp_ge_u32 s52, 1
    s_cbranch_scc1 LWD_76
    s_sleep 16
    s_sub_u32 s63, s63, 1
    s_cmp_lg_u32 s63, 0
    s_cbranch_scc1 LW_75
LWD_76:
    s_mov_b32 s56, 21061632
    v_and_b32 v4, 63, v1
    v_lshlrev_b32 v4, 7, v4
    s_mov_b32 s63, 200000
POLL_77:
    buffer_load_dwordx2 v[2:3], v4, s[44:47], s56 offen sc1
    s_waitcnt vmcnt(0)
    v_cmp_ne_u64 vcc, s[30:31], v[2:3]
    s_nop 1
    s_cmp_eq_u64 vcc, 0
    s_cbranch_scc1 POLLD_78
    s_sleep 8
    s_sub_u32 s63, s63, 1
    s_cmp_lg_u32 s63, 0
    s_cbranch_scc1 POLL_77
POLLD_78:
    v_mov_b32 v2, 257
    ds_add_u32 v13, v2 offset:280
    s_branch G_F1DONE
G_F1GO:
    s_mov_b32 s63, 1600000
LW_79:
    ds_read_b32 v2, v12 offset:336
    s_waitcnt lgkmcnt(0)
    v_readfirstlane_b32 s52, v2
    s_nop 1
    s_cmp_ge_u32 s52, 1028
    s_cbranch_scc1 LWD_80
    s_sleep 2
    s_sub_u32 s63, s63, 1
    s_cmp_lg_u32 s63, 0
    s_cbranch_scc1 LW_79
LWD_80:
    s_mov_b32 s63, 1600000
LW_81:
    ds_read_b32 v2, v12 offset:344
    s_waitcnt lgkmcnt(0)
    v_readfirstlane_b32 s52, v2
    s_nop 1
    s_cmp_ge_u32 s52, 12
    s_cbranch_scc1 LWD_82
    s_sleep 2
    s_sub_u32 s63, s63, 1
    s_cmp_lg_u32 s63, 0
    s_cbranch_scc1 LW_81
LWD_82:
    s_mov_b32 s32, s16
    s_mov_b32 s33, s17
    s_mov_b32 s34, 2211840
    s_mov_b32 s35, 0x20000
    s_mov_b32 s36, s18
    s_mov_b32 s37, s19
    s_mov_b32 s38, 3456
    s_mov_b32 s39, 0x20000
    v_lshrrev_b32 v2, 3, v1
    v_and_b32 v3, 7, v1
    v_mul_u32_u24 v14, 3456, v2
    v_lshl_add_u32 v14, v3, 4, v14
    s_lshl_b32 s56, s62, 2
    s_lshl_b32 s60, s54, 7
    v_bfe_u32 v4, v1, 4, 1
    v_lshlrev_b32 v4, 5, v4
    v_bfe_u32 v5, v1, 2, 1
    v_lshl_add_u32 v4, v5, 4, v4
    v_bfe_u32 v5, v1, 3, 1
    v_lshl_add_u32 v4, v5, 3, v4
    v_and_b32 v5, 3, v1
    v_lshl_add_u32 v4, v5, 1, v4
    buffer_load_ushort v152, v4, s[36:39], s60 offen offset:0
    buffer_load_ushort v153, v4, s[36:39], s60 offen offset:64
    s_mul_i32 s57, s56, 55296
    s_add_u32 s57, s57, s60
    buffer_load_dwordx4 v[88:91], v14, s[32:35], s57 offen
    s_add_u32 s57, s57, 27648
    s_add_u32 s56, s56, 1
    buffer_load_dwordx4 v[92:95], v14, s[32:35], s57 offen
    s_cmp_eq_u32 s56, 40
    s_cselect_b32 s56, 0, s56
    s_mul_i32 s57, s56, 55296
    s_add_u32 s57, s57, s60
    buffer_load_dwordx4 v[96:99], v14, s[32:35], s57 offen
    s_add_u32 s57, s57, 27648
    s_add_u32 s56, s56, 1
    buffer_load_dwordx4 v[100:103], v14, s[32:35], s57 offen
    s_cmp_eq_u32 s56, 40
    s_cselect_b32 s56, 0, s56
    s_mul_i32 s57, s56, 55296
    s_add_u32 s57, s57, s60
    buffer_load_dwordx4 v[104:107], v14, s[32:35], s57 offen
    s_add_u32 s57, s57, 27648
    s_add_u32 s56, s56, 1
    buffer_load_dwordx4 v[108:111], v14, s[32:35], s57 offen
    s_cmp_eq_u32 s56, 40
    s_cselect_b32 s56, 0, s56
    s_mul_i32 s57, s56, 55296
    s_add_u32 s57, s57, s60
    buffer_load_dwordx4 v[112:115], v14, s[32:35], s57 offen
    s_add_u32 s57, s57, 27648
    s_add_u32 s56, s56, 1
    buffer_load_dwordx4 v[116:119], v14, s[32:35], s57 offen
    s_cmp_eq_u32 s56, 40
    s_cselect_b32 s56, 0, s56
    s_mul_i32 s57, s56, 55296
    s_add_u32 s57, s57, s60
    buffer_load_dwordx4 v[120:123], v14, s[32:35], s57 offen
    s_add_u32 s57, s57, 27648
    s_add_u32 s56, s56, 1
    buffer_load_dwordx4 v[124:127], v14, s[32:35], s57 offen
    s_cmp_eq_u32 s56, 40
    s_cselect_b32 s56, 0, s56
    s_mul_i32 s57, s56, 55296
    s_add_u32 s57, s57, s60
    buffer_load_dwordx4 v[128:131], v14, s[32:35], s57 offen
    s_add_u32 s57, s57, 27648
    s_add_u32 s56, s56, 1
    buffer_load_dwordx4 v[132:135], v14, s[32:35], s57 offen
    s_cmp_eq_u32 s56, 40
    s_cselect_b32 s56, 0, s56
    s_mul_i32 s53, s61, 4352
    s_sub_u32 s53, 158464, s53
    v_and_b32 v5, 1, v2
    v_lshrrev_b32 v4, 1, v2
    v_lshl_add_u32 v4, v5, 2, v4
    v_lshlrev_b32 v4, 6, v4
    v_and_b32 v5, 3, v3
    v_lshl_add_u32 v4, v5, 4, v4
    v_lshrrev_b32 v5, 2, v3
    v_mul_u32_u24 v5, 1088, v5
    v_add3_u32 v21, v4, v5, s53
    v_bfe_u32 v2, v1, 2, 2
    v_lshl_add_u32 v2, v7, 3, v2
    v_bfe_u32 v3, v1, 4, 1
    v_and_b32 v5, 3, v1
    v_lshl_add_u32 v3, v3, 2, v5
    v_lshlrev_b32 v2, 6, v2
    v_add_u32 v2, s53, v2
    v_lshrrev_b32 v5, 2, v3
    v_lshl_add_u32 v2, v5, 5, v2
    v_and_b32 v5, 1, v3
    v_lshl_add_u32 v2, v5, 4, v2
    v_bfe_u32 v5, v3, 1, 1
    v_lshl_add_u32 v19, v5, 3, v2
    s_mov_b32 s52, 45056
    v_add_u32 v2, 0, v7
    v_xor_b32 v2, v2, v6
    v_lshlrev_b32 v2, 4, v2
    v_lshl_add_u32 v2, v7, 9, v2
    v_add_u32 v8, s52, v2
    v_add_u32 v2, 2, v7
    v_xor_b32 v2, v2, v6
    v_lshlrev_b32 v2, 4, v2
    v_lshl_add_u32 v2, v7, 9, v2
    v_add_u32 v9, s52, v2
    v_add_u32 v2, 4, v7
    v_xor_b32 v2, v2, v6
    v_lshlrev_b32 v2, 4, v2
    v_lshl_add_u32 v2, v7, 9, v2
    v_add_u32 v10, s52, v2
    v_add_u32 v2, 6, v7
    v_xor_b32 v2, v2, v6
    v_lshlrev_b32 v2, 4, v2
    v_lshl_add_u32 v2, v7, 9, v2
    v_add_u32 v11, s52, v2
    v_add_u32 v15, 40960, v8
    v_add_u32 v16, 40960, v9
    v_add_u32 v17, 40960, v10
    v_add_u32 v18, 40960, v11
    s_mov_b32 s63, 1600000
LW_83:
    ds_read_b32 v2, v12 offset:288
    s_waitcnt lgkmcnt(0)
    v_readfirstlane_b32 s52, v2
    s_nop 1
    s_cmp_ge_u32 s52, 2
    s_cbranch_scc1 LWD_84
    s_sleep 1
    s_sub_u32 s63, s63, 1
    s_cmp_lg_u32 s63, 0
    s_cbranch_scc1 LW_83
LWD_84:
    s_mov_b32 s63, 1600000
LW_85:
    ds_read_b32 v2, v12 offset:348
    s_waitcnt lgkmcnt(0)
    v_readfirstlane_b32 s52, v2
    s_nop 1
    s_cmp_ge_u32 s52, 1028
    s_cbranch_scc1 LWD_86
    s_sleep 1
    s_sub_u32 s63, s63, 1
    s_cmp_lg_u32 s63, 0
    s_cbranch_scc1 LW_85
LWD_86:
    s_cmp_eq_u32 s61, 3
    s_cselect_b32 s59, 4, 0
    s_mov_b32 s63, 1600000
LW_87:
    ds_read_b32 v2, v12 offset:320
    s_waitcnt lgkmcnt(0)
    v_readfirstlane_b32 s52, v2
    s_nop 1
    s_cmp_ge_u32 s52, s59
    s_cbranch_scc1 LWD_88
    s_sleep 1
    s_sub_u32 s63, s63, 1
    s_cmp_lg_u32 s63, 0
    s_cbranch_scc1 LW_87
LWD_88:
    v_lshlrev_b32 v2, 2, v6
    v_add_u32 v2, 162816, v2
    ds_read_b32 v0, v2
    ds_read_b32 v23, v2 offset:128
    s_waitcnt lgkmcnt(0)
    v_rcp_f32 v0, v0
    v_rcp_f32 v23, v23
    v_cmp_eq_u32 vcc, 0, v7
    v_mov_b32 v137, 0
    v_mov_b32 v138, 0
    v_mov_b32 v139, 0
    v_mov_b32 v141, 0
    v_mov_b32 v142, 0
    v_mov_b32 v143, 0
    v_mov_b32 v145, 0
    v_mov_b32 v146, 0
    v_mov_b32 v147, 0
    v_mov_b32 v149, 0
    v_mov_b32 v150, 0
    v_mov_b32 v151, 0
    v_and_b32 v2, 0xffff0000, v0
    v_sub_f32 v3, v0, v2
    v_cvt_pk_bf16_f32 v2, v2, v3
    v_cndmask_b32 v144, 0, v2, vcc
    v_and_b32 v2, 0xffff0000, v23
    v_sub_f32 v3, v23, v2
    v_cvt_pk_bf16_f32 v2, v2, v3
    v_cndmask_b32 v148, 0, v2, vcc
    s_waitcnt vmcnt(12)
    v_lshl_or_b32 v136, v152, 16, v152
    v_lshl_or_b32 v140, v153, 16, v153
    s_nop 1
    v_mfma_f32_32x32x16_bf16 v[24:39], v[136:139], v[144:147], 0
    v_mfma_f32_32x32x16_bf16 v[40:55], v[136:139], v[148:151], 0
    v_mfma_f32_32x32x16_bf16 v[56:71], v[140:143], v[144:147], 0
    v_mfma_f32_32x32x16_bf16 v[72:87], v[140:143], v[148:151], 0
    s_setprio 0
    s_waitcnt vmcnt(10)
    ds_write_b128 v21, v[88:91] offset:0
    ds_write_b128 v21, v[92:95] offset:512
    ds_read_b64_tr_b16 v[136:137], v19 offset:0
    ds_read_b64_tr_b16 v[138:139], v19 offset:256
    ds_read_b64_tr_b16 v[140:141], v19 offset:1088
    ds_read_b64_tr_b16 v[142:143], v19 offset:1344
    ds_read_b128 v[144:147], v8 offset:0
    ds_read_b128 v[148:151], v15 offset:0
    s_waitcnt vmcnt(8)
    ds_write_b128 v21, v[96:99] offset:2176
    ds_write_b128 v21, v[100:103] offset:2688
    s_waitcnt lgkmcnt(2)
    v_mfma_f32_32x32x16_bf16 v[24:39], v[136:139], v[144:147], v[24:39]
    ds_read_b64_tr_b16 v[152:153], v19 offset:2176
    ds_read_b64_tr_b16 v[154:155], v19 offset:2432
    ds_read_b64_tr_b16 v[156:157], v19 offset:3264
    ds_read_b64_tr_b16 v[158:159], v19 offset:3520
    ds_read_b128 v[160:163], v9 offset:1024
    ds_read_b128 v[164:167], v16 offset:1024
    v_mfma_f32_32x32x16_bf16 v[40:55], v[136:139], v[148:151], v[40:55]
    s_waitcnt vmcnt(6)
    ds_write_b128 v21, v[104:107] offset:0
    ds_write_b128 v21, v[108:111] offset:512
    v_mfma_f32_32x32x16_bf16 v[56:71], v[140:143], v[144:147], v[56:71]
    s_mul_i32 s57, s56, 55296
    s_add_u32 s57, s57, s60
    buffer_load_dwordx4 v[88:91], v14, s[32:35], s57 offen
    s_add_u32 s57, s57, 27648
    s_add_u32 s56, s56, 1
    buffer_load_dwordx4 v[92:95], v14, s[32:35], s57 offen
    s_cmp_eq_u32 s56, 40
    s_cselect_b32 s56, 0, s56
    v_mfma_f32_32x32x16_bf16 v[72:87], v[140:143], v[148:151], v[72:87]
    s_waitcnt lgkmcnt(2)
    v_mfma_f32_32x32x16_bf16 v[24:39], v[152:155], v[160:163], v[24:39]
    ds_read_b64_tr_b16 v[136:137], v19 offset:0
    ds_read_b64_tr_b16 v[138:139], v19 offset:256
    ds_read_b64_tr_b16 v[140:141], v19 offset:1088
    ds_read_b64_tr_b16 v[142:143], v19 offset:1344
    ds_read_b128 v[144:147], v10 offset:2048
    ds_read_b128 v[148:151], v17 offset:2048
    v_mfma_f32_32x32x16_bf16 v[40:55], v[152:155], v[164:167], v[40:55]
    s_waitcnt vmcnt(6)
    ds_write_b128 v21, v[112:115] offset:2176
    ds_write_b128 v21, v[116:119] offset:2688
    v_mfma_f32_32x32x16_bf16 v[56:71], v[156:159], v[160:163], v[56:71]
    s_mul_i32 s57, s56, 55296
    s_add_u32 s57, s57, s60
    buffer_load_dwordx4 v[96:99], v14, s[32:35], s57 offen
    s_add_u32 s57, s57, 27648
    s_add_u32 s56, s56, 1
    buffer_load_dwordx4 v[100:103], v14, s[32:35], s57 offen
    s_cmp_eq_u32 s56, 40
    s_cselect_b32 s56, 0, s56
    v_mfma_f32_32x32x16_bf16 v[72:87], v[156:159], v[164:167], v[72:87]
    s_waitcnt lgkmcnt(2)
    v_mfma_f32_32x32x16_bf16 v[24:39], v[136:139], v[144:147], v[24:39]
    ds_read_b64_tr_b16 v[152:153], v19 offset:2176
    ds_read_b64_tr_b16 v[154:155], v19 offset:2432
    ds_read_b64_tr_b16 v[156:157], v19 offset:3264
    ds_read_b64_tr_b16 v[158:159], v19 offset:3520
    ds_read_b128 v[160:163], v11 offset:3072
    ds_read_b128 v[164:167], v18 offset:3072
    v_mfma_f32_32x32x16_bf16 v[40:55], v[136:139], v[148:151], v[40:55]
    s_waitcnt vmcnt(6)
    ds_write_b128 v21, v[120:123] offset:0
    ds_write_b128 v21, v[124:127] offset:512
    v_mfma_f32_32x32x16_bf16 v[56:71], v[140:143], v[144:147], v[56:71]
    s_mul_i32 s57, s56, 55296
    s_add_u32 s57, s57, s60
    buffer_load_dwordx4 v[104:107], v14, s[32:35], s57 offen
    s_add_u32 s57, s57, 27648
    s_add_u32 s56, s56, 1
    buffer_load_dwordx4 v[108:111], v14, s[32:35], s57 offen
    s_cmp_eq_u32 s56, 40
    s_cselect_b32 s56, 0, s56
    v_mfma_f32_32x32x16_bf16 v[72:87], v[140:143], v[148:151], v[72:87]
    s_waitcnt lgkmcnt(2)
    v_mfma_f32_32x32x16_bf16 v[24:39], v[152:155], v[160:163], v[24:39]
    ds_read_b64_tr_b16 v[136:137], v19 offset:0
    ds_read_b64_tr_b16 v[138:139], v19 offset:256
    ds_read_b64_tr_b16 v[140:141], v19 offset:1088
    ds_read_b64_tr_b16 v[142:143], v19 offset:1344
    ds_read_b128 v[144:147], v8 offset:4096
    ds_read_b128 v[148:151], v15 offset:4096
    v_mfma_f32_32x32x16_bf16 v[40:55], v[152:155], v[164:167], v[40:55]
    s_waitcnt vmcnt(6)
    ds_write_b128 v21, v[128:131] offset:2176
    ds_write_b128 v21, v[132:135] offset:2688
    v_mfma_f32_32x32x16_bf16 v[56:71], v[156:159], v[160:163], v[56:71]
    s_mul_i32 s57, s56, 55296
    s_add_u32 s57, s57, s60
    buffer_load_dwordx4 v[112:115], v14, s[32:35], s57 offen
    s_add_u32 s57, s57, 27648
    s_add_u32 s56, s56, 1
    buffer_load_dwordx4 v[116:119], v14, s[32:35], s57 offen
    s_cmp_eq_u32 s56, 40
    s_cselect_b32 s56, 0, s56
    v_mfma_f32_32x32x16_bf16 v[72:87], v[156:159], v[164:167], v[72:87]
    s_waitcnt lgkmcnt(2)
    v_mfma_f32_32x32x16_bf16 v[24:39], v[136:139], v[144:147], v[24:39]
    ds_read_b64_tr_b16 v[152:153], v19 offset:2176
    ds_read_b64_tr_b16 v[154:155], v19 offset:2432
    ds_read_b64_tr_b16 v[156:157], v19 offset:3264
    ds_read_b64_tr_b16 v[158:159], v19 offset:3520
    ds_read_b128 v[160:163], v9 offset:5120
    ds_read_b128 v[164:167], v16 offset:5120
    v_mfma_f32_32x32x16_bf16 v[40:55], v[136:139], v[148:151], v[40:55]
    s_waitcnt vmcnt(6)
    ds_write_b128 v21, v[88:91] offset:0
    ds_write_b128 v21, v[92:95] offset:512
    v_mfma_f32_32x32x16_bf16 v[56:71], v[140:143], v[144:147], v[56:71]
    s_mul_i32 s57, s56, 55296
    s_add_u32 s57, s57, s60
    buffer_load_dwordx4 v[120:123], v14, s[32:35], s57 offen
    s_add_u32 s57, s57, 27648
    s_add_u32 s56, s56, 1
    buffer_load_dwordx4 v[124:127], v14, s[32:35], s57 offen
    s_cmp_eq_u32 s56, 40
    s_cselect_b32 s56, 0, s56
    v_mfma_f32_32x32x16_bf16 v[72:87], v[140:143], v[148:151], v[72:87]
    s_waitcnt lgkmcnt(2)
    v_mfma_f32_32x32x16_bf16 v[24:39], v[152:155], v[160:163], v[24:39]
    ds_read_b64_tr_b16 v[136:137], v19 offset:0
    ds_read_b64_tr_b16 v[138:139], v19 offset:256
    ds_read_b64_tr_b16 v[140:141], v19 offset:1088
    ds_read_b64_tr_b16 v[142:143], v19 offset:1344
    ds_read_b128 v[144:147], v10 offset:6144
    ds_read_b128 v[148:151], v17 offset:6144
    v_mfma_f32_32x32x16_bf16 v[40:55], v[152:155], v[164:167], v[40:55]
    s_waitcnt vmcnt(6)
    ds_write_b128 v21, v[96:99] offset:2176
    ds_write_b128 v21, v[100:103] offset:2688
    v_mfma_f32_32x32x16_bf16 v[56:71], v[156:159], v[160:163], v[56:71]
    s_mul_i32 s57, s56, 55296
    s_add_u32 s57, s57, s60
    buffer_load_dwordx4 v[128:131], v14, s[32:35], s57 offen
    s_add_u32 s57, s57, 27648
    s_add_u32 s56, s56, 1
    buffer_load_dwordx4 v[132:135], v14, s[32:35], s57 offen
    s_cmp_eq_u32 s56, 40
    s_cselect_b32 s56, 0, s56
    v_mfma_f32_32x32x16_bf16 v[72:87], v[156:159], v[164:167], v[72:87]
    s_waitcnt lgkmcnt(2)
    v_mfma_f32_32x32x16_bf16 v[24:39], v[136:139], v[144:147], v[24:39]
    ds_read_b64_tr_b16 v[152:153], v19 offset:2176
    ds_read_b64_tr_b16 v[154:155], v19 offset:2432
    ds_read_b64_tr_b16 v[156:157], v19 offset:3264
    ds_read_b64_tr_b16 v[158:159], v19 offset:3520
    ds_read_b128 v[160:163], v11 offset:7168
    ds_read_b128 v[164:167], v18 offset:7168
    v_mfma_f32_32x32x16_bf16 v[40:55], v[136:139], v[148:151], v[40:55]
    s_waitcnt vmcnt(6)
    ds_write_b128 v21, v[104:107] offset:0
    ds_write_b128 v21, v[108:111] offset:512
    v_mfma_f32_32x32x16_bf16 v[56:71], v[140:143], v[144:147], v[56:71]
    s_mul_i32 s57, s56, 55296
    s_add_u32 s57, s57, s60
    buffer_load_dwordx4 v[88:91], v14, s[32:35], s57 offen
    s_add_u32 s57, s57, 27648
    s_add_u32 s56, s56, 1
    buffer_load_dwordx4 v[92:95], v14, s[32:35], s57 offen
    s_cmp_eq_u32 s56, 40
    s_cselect_b32 s56, 0, s56
    v_mfma_f32_32x32x16_bf16 v[72:87], v[140:143], v[148:151], v[72:87]
    s_waitcnt lgkmcnt(2)
    v_mfma_f32_32x32x16_bf16 v[24:39], v[152:155], v[160:163], v[24:39]
    ds_read_b64_tr_b16 v[136:137], v19 offset:0
    ds_read_b64_tr_b16 v[138:139], v19 offset:256
    ds_read_b64_tr_b16 v[140:141], v19 offset:1088
    ds_read_b64_tr_b16 v[142:143], v19 offset:1344
    ds_read_b128 v[144:147], v8 offset:8192
    ds_read_b128 v[148:151], v15 offset:8192
    v_mfma_f32_32x32x16_bf16 v[40:55], v[152:155], v[164:167], v[40:55]
    s_waitcnt vmcnt(6)
    ds_write_b128 v21, v[112:115] offset:2176
    ds_write_b128 v21, v[116:119] offset:2688
    v_mfma_f32_32x32x16_bf16 v[56:71], v[156:159], v[160:163], v[56:71]
    s_mul_i32 s57, s56, 55296
    s_add_u32 s57, s57, s60
    buffer_load_dwordx4 v[96:99], v14, s[32:35], s57 offen
    s_add_u32 s57, s57, 27648
    s_add_u32 s56, s56, 1
    buffer_load_dwordx4 v[100:103], v14, s[32:35], s57 offen
    s_cmp_eq_u32 s56, 40
    s_cselect_b32 s56, 0, s56
    v_mfma_f32_32x32x16_bf16 v[72:87], v[156:159], v[164:167], v[72:87]
    s_waitcnt lgkmcnt(2)
    v_mfma_f32_32x32x16_bf16 v[24:39], v[136:139], v[144:147], v[24:39]
    ds_read_b64_tr_b16 v[152:153], v19 offset:2176
    ds_read_b64_tr_b16 v[154:155], v19 offset:2432
    ds_read_b64_tr_b16 v[156:157], v19 offset:3264
    ds_read_b64_tr_b16 v[158:159], v19 offset:3520
    ds_read_b128 v[160:163], v9 offset:9216
    ds_read_b128 v[164:167], v16 offset:9216
    v_mfma_f32_32x32x16_bf16 v[40:55], v[136:139], v[148:151], v[40:55]
    s_waitcnt vmcnt(6)
    ds_write_b128 v21, v[120:123] offset:0
    ds_write_b128 v21, v[124:127] offset:512
    v_mfma_f32_32x32x16_bf16 v[56:71], v[140:143], v[144:147], v[56:71]
    s_mul_i32 s57, s56, 55296
    s_add_u32 s57, s57, s60
    buffer_load_dwordx4 v[104:107], v14, s[32:35], s57 offen
    s_add_u32 s57, s57, 27648
    s_add_u32 s56, s56, 1
    buffer_load_dwordx4 v[108:111], v14, s[32:35], s57 offen
    s_cmp_eq_u32 s56, 40
    s_cselect_b32 s56, 0, s56
    v_mfma_f32_32x32x16_bf16 v[72:87], v[140:143], v[148:151], v[72:87]
    s_waitcnt lgkmcnt(2)
    v_mfma_f32_32x32x16_bf16 v[24:39], v[152:155], v[160:163], v[24:39]
    ds_read_b64_tr_b16 v[136:137], v19 offset:0
    ds_read_b64_tr_b16 v[138:139], v19 offset:256
    ds_read_b64_tr_b16 v[140:141], v19 offset:1088
    ds_read_b64_tr_b16 v[142:143], v19 offset:1344
    ds_read_b128 v[144:147], v10 offset:10240
    ds_read_b128 v[148:151], v17 offset:10240
    v_mfma_f32_32x32x16_bf16 v[40:55], v[152:155], v[164:167], v[40:55]
    s_waitcnt vmcnt(6)
    ds_write_b128 v21, v[128:131] offset:2176
    ds_write_b128 v21, v[132:135] offset:2688
    v_mfma_f32_32x32x16_bf16 v[56:71], v[156:159], v[160:163], v[56:71]
    s_mul_i32 s57, s56, 55296
    s_add_u32 s57, s57, s60
    buffer_load_dwordx4 v[112:115], v14, s[32:35], s57 offen
    s_add_u32 s57, s57, 27648
    s_add_u32 s56, s56, 1
    buffer_load_dwordx4 v[116:119], v14, s[32:35], s57 offen
    s_cmp_eq_u32 s56, 40
    s_cselect_b32 s56, 0, s56
    v_mfma_f32_32x32x16_bf16 v[72:87], v[156:159], v[164:167], v[72:87]
    s_waitcnt lgkmcnt(2)
    v_mfma_f32_32x32x16_bf16 v[24:39], v[136:139], v[144:147], v[24:39]
    ds_read_b64_tr_b16 v[152:153], v19 offset:2176
    ds_read_b64_tr_b16 v[154:155], v19 offset:2432
    ds_read_b64_tr_b16 v[156:157], v19 offset:3264
    ds_read_b64_tr_b16 v[158:159], v19 offset:3520
    ds_read_b128 v[160:163], v11 offset:11264
    ds_read_b128 v[164:167], v18 offset:11264
    v_mfma_f32_32x32x16_bf16 v[40:55], v[136:139], v[148:151], v[40:55]
    s_waitcnt vmcnt(6)
    ds_write_b128 v21, v[88:91] offset:0
    ds_write_b128 v21, v[92:95] offset:512
    v_mfma_f32_32x32x16_bf16 v[56:71], v[140:143], v[144:147], v[56:71]
    s_mul_i32 s57, s56, 55296
    s_add_u32 s57, s57, s60
    buffer_load_dwordx4 v[120:123], v14, s[32:35], s57 offen
    s_add_u32 s57, s57, 27648
    s_add_u32 s56, s56, 1
    buffer_load_dwordx4 v[124:127], v14, s[32:35], s57 offen
    s_cmp_eq_u32 s56, 40
    s_cselect_b32 s56, 0, s56
    v_mfma_f32_32x32x16_bf16 v[72:87], v[140:143], v[148:151], v[72:87]
    s_waitcnt lgkmcnt(2)
    v_mfma_f32_32x32x16_bf16 v[24:39], v[152:155], v[160:163], v[24:39]
    ds_read_b64_tr_b16 v[136:137], v19 offset:0
    ds_read_b64_tr_b16 v[138:139], v19 offset:256
    ds_read_b64_tr_b16 v[140:141], v19 offset:1088
    ds_read_b64_tr_b16 v[142:143], v19 offset:1344
    ds_read_b128 v[144:147], v8 offset:12288
    ds_read_b128 v[148:151], v15 offset:12288
    v_mfma_f32_32x32x16_bf16 v[40:55], v[152:155], v[164:167], v[40:55]
    s_waitcnt vmcnt(6)
    ds_write_b128 v21, v[96:99] offset:2176
    ds_write_b128 v21, v[100:103] offset:2688
    v_mfma_f32_32x32x16_bf16 v[56:71], v[156:159], v[160:163], v[56:71]
    s_mul_i32 s57, s56, 55296
    s_add_u32 s57, s57, s60
    buffer_load_dwordx4 v[128:131], v14, s[32:35], s57 offen
    s_add_u32 s57, s57, 27648
    s_add_u32 s56, s56, 1
    buffer_load_dwordx4 v[132:135], v14, s[32:35], s57 offen
    s_cmp_eq_u32 s56, 40
    s_cselect_b32 s56, 0, s56
    v_mfma_f32_32x32x16_bf16 v[72:87], v[156:159], v[164:167], v[72:87]
    s_waitcnt lgkmcnt(2)
    v_mfma_f32_32x32x16_bf16 v[24:39], v[136:139], v[144:147], v[24:39]
    ds_read_b64_tr_b16 v[152:153], v19 offset:2176
    ds_read_b64_tr_b16 v[154:155], v19 offset:2432
    ds_read_b64_tr_b16 v[156:157], v19 offset:3264
    ds_read_b64_tr_b16 v[158:159], v19 offset:3520
    ds_read_b128 v[160:163], v9 offset:13312
    ds_read_b128 v[164:167], v16 offset:13312
    v_mfma_f32_32x32x16_bf16 v[40:55], v[136:139], v[148:151], v[40:55]
    s_waitcnt vmcnt(6)
    ds_write_b128 v21, v[104:107] offset:0
    ds_write_b128 v21, v[108:111] offset:512
    v_mfma_f32_32x32x16_bf16 v[56:71], v[140:143], v[144:147], v[56:71]
    s_mul_i32 s57, s56, 55296
    s_add_u32 s57, s57, s60
    buffer_load_dwordx4 v[88:91], v14, s[32:35], s57 offen
    s_add_u32 s57, s57, 27648
    s_add_u32 s56, s56, 1
    buffer_load_dwordx4 v[92:95], v14, s[32:35], s57 offen
    s_cmp_eq_u32 s56, 40
    s_cselect_b32 s56, 0, s56
    v_mfma_f32_32x32x16_bf16 v[72:87], v[140:143], v[148:151], v[72:87]
    s_waitcnt lgkmcnt(2)
    v_mfma_f32_32x32x16_bf16 v[24:39], v[152:155], v[160:163], v[24:39]
    ds_read_b64_tr_b16 v[136:137], v19 offset:0
    ds_read_b64_tr_b16 v[138:139], v19 offset:256
    ds_read_b64_tr_b16 v[140:141], v19 offset:1088
    ds_read_b64_tr_b16 v[142:143], v19 offset:1344
    ds_read_b128 v[144:147], v10 offset:14336
    ds_read_b128 v[148:151], v17 offset:14336
    v_mfma_f32_32x32x16_bf16 v[40:55], v[152:155], v[164:167], v[40:55]
    s_waitcnt vmcnt(6)
    ds_write_b128 v21, v[112:115] offset:2176
    ds_write_b128 v21, v[116:119] offset:2688
    v_mfma_f32_32x32x16_bf16 v[56:71], v[156:159], v[160:163], v[56:71]
    s_mul_i32 s57, s56, 55296
    s_add_u32 s57, s57, s60
    buffer_load_dwordx4 v[96:99], v14, s[32:35], s57 offen
    s_add_u32 s57, s57, 27648
    s_add_u32 s56, s56, 1
    buffer_load_dwordx4 v[100:103], v14, s[32:35], s57 offen
    s_cmp_eq_u32 s56, 40
    s_cselect_b32 s56, 0, s56
    v_mfma_f32_32x32x16_bf16 v[72:87], v[156:159], v[164:167], v[72:87]
    s_waitcnt lgkmcnt(2)
    v_mfma_f32_32x32x16_bf16 v[24:39], v[136:139], v[144:147], v[24:39]
    ds_read_b64_tr_b16 v[152:153], v19 offset:2176
    ds_read_b64_tr_b16 v[154:155], v19 offset:2432
    ds_read_b64_tr_b16 v[156:157], v19 offset:3264
    ds_read_b64_tr_b16 v[158:159], v19 offset:3520
    ds_read_b128 v[160:163], v11 offset:15360
    ds_read_b128 v[164:167], v18 offset:15360
    v_mfma_f32_32x32x16_bf16 v[40:55], v[136:139], v[148:151], v[40:55]
    s_waitcnt vmcnt(6)
    ds_write_b128 v21, v[120:123] offset:0
    ds_write_b128 v21, v[124:127] offset:512
    v_mfma_f32_32x32x16_bf16 v[56:71], v[140:143], v[144:147], v[56:71]
    s_mul_i32 s57, s56, 55296
    s_add_u32 s57, s57, s60
    buffer_load_dwordx4 v[104:107], v14, s[32:35], s57 offen
    s_add_u32 s57, s57, 27648
    s_add_u32 s56, s56, 1
    buffer_load_dwordx4 v[108:111], v14, s[32:35], s57 offen
    s_cmp_eq_u32 s56, 40
    s_cselect_b32 s56, 0, s56
    v_mfma_f32_32x32x16_bf16 v[72:87], v[140:143], v[148:151], v[72:87]
    s_waitcnt lgkmcnt(2)
    v_mfma_f32_32x32x16_bf16 v[24:39], v[152:155], v[160:163], v[24:39]
    ds_read_b64_tr_b16 v[136:137], v19 offset:0
    ds_read_b64_tr_b16 v[138:139], v19 offset:256
    ds_read_b64_tr_b16 v[140:141], v19 offset:1088
    ds_read_b64_tr_b16 v[142:143], v19 offset:1344
    ds_read_b128 v[144:147], v8 offset:16384
    ds_read_b128 v[148:151], v15 offset:16384
    v_mfma_f32_32x32x16_bf16 v[40:55], v[152:155], v[164:167], v[40:55]
    s_waitcnt vmcnt(6)
    ds_write_b128 v21, v[128:131] offset:2176
    ds_write_b128 v21, v[132:135] offset:2688
    v_mfma_f32_32x32x16_bf16 v[56:71], v[156:159], v[160:163], v[56:71]
    s_mul_i32 s57, s56, 55296
    s_add_u32 s57, s57, s60
    buffer_load_dwordx4 v[112:115], v14, s[32:35], s57 offen
    s_add_u32 s57, s57, 27648
    s_add_u32 s56, s56, 1
    buffer_load_dwordx4 v[116:119], v14, s[32:35], s57 offen
    s_cmp_eq_u32 s56, 40
    s_cselect_b32 s56, 0, s56
    v_mfma_f32_32x32x16_bf16 v[72:87], v[156:159], v[164:167], v[72:87]
    s_waitcnt lgkmcnt(2)
    v_mfma_f32_32x32x16_bf16 v[24:39], v[136:139], v[144:147], v[24:39]
    ds_read_b64_tr_b16 v[152:153], v19 offset:2176
    ds_read_b64_tr_b16 v[154:155], v19 offset:2432
    ds_read_b64_tr_b16 v[156:157], v19 offset:3264
    ds_read_b64_tr_b16 v[158:159], v19 offset:3520
    ds_read_b128 v[160:163], v9 offset:17408
    ds_read_b128 v[164:167], v16 offset:17408
    v_mfma_f32_32x32x16_bf16 v[40:55], v[136:139], v[148:151], v[40:55]
    s_waitcnt vmcnt(6)
    ds_write_b128 v21, v[88:91] offset:0
    ds_write_b128 v21, v[92:95] offset:512
    v_mfma_f32_32x32x16_bf16 v[56:71], v[140:143], v[144:147], v[56:71]
    s_mul_i32 s57, s56, 55296
    s_add_u32 s57, s57, s60
    buffer_load_dwordx4 v[120:123], v14, s[32:35], s57 offen
    s_add_u32 s57, s57, 27648
    s_add_u32 s56, s56, 1
    buffer_load_dwordx4 v[124:127], v14, s[32:35], s57 offen
    s_cmp_eq_u32 s56, 40
    s_cselect_b32 s56, 0, s56
    v_mfma_f32_32x32x16_bf16 v[72:87], v[140:143], v[148:151], v[72:87]
    s_waitcnt lgkmcnt(2)
    v_mfma_f32_32x32x16_bf16 v[24:39], v[152:155], v[160:163], v[24:39]
    ds_read_b64_tr_b16 v[136:137], v19 offset:0
    ds_read_b64_tr_b16 v[138:139], v19 offset:256
    ds_read_b64_tr_b16 v[140:141], v19 offset:1088
    ds_read_b64_tr_b16 v[142:143], v19 offset:1344
    ds_read_b128 v[144:147], v10 offset:18432
    ds_read_b128 v[148:151], v17 offset:18432
    v_mfma_f32_32x32x16_bf16 v[40:55], v[152:155], v[164:167], v[40:55]
    s_waitcnt vmcnt(6)
    ds_write_b128 v21, v[96:99] offset:2176
    ds_write_b128 v21, v[100:103] offset:2688
    v_mfma_f32_32x32x16_bf16 v[56:71], v[156:159], v[160:163], v[56:71]
    s_mul_i32 s57, s56, 55296
    s_add_u32 s57, s57, s60
    buffer_load_dwordx4 v[128:131], v14, s[32:35], s57 offen
    s_add_u32 s57, s57, 27648
    s_add_u32 s56, s56, 1
    buffer_load_dwordx4 v[132:135], v14, s[32:35], s57 offen
    s_cmp_eq_u32 s56, 40
    s_cselect_b32 s56, 0, s56
    v_mfma_f32_32x32x16_bf16 v[72:87], v[156:159], v[164:167], v[72:87]
    s_waitcnt lgkmcnt(2)
    v_mfma_f32_32x32x16_bf16 v[24:39], v[136:139], v[144:147], v[24:39]
    ds_read_b64_tr_b16 v[152:153], v19 offset:2176
    ds_read_b64_tr_b16 v[154:155], v19 offset:2432
    ds_read_b64_tr_b16 v[156:157], v19 offset:3264
    ds_read_b64_tr_b16 v[158:159], v19 offset:3520
    ds_read_b128 v[160:163], v11 offset:19456
    ds_read_b128 v[164:167], v18 offset:19456
    v_mfma_f32_32x32x16_bf16 v[40:55], v[136:139], v[148:151], v[40:55]
    s_waitcnt vmcnt(6)
    ds_write_b128 v21, v[104:107] offset:0
    ds_write_b128 v21, v[108:111] offset:512
    v_mfma_f32_32x32x16_bf16 v[56:71], v[140:143], v[144:147], v[56:71]
    s_mul_i32 s57, s56, 55296
    s_add_u32 s57, s57, s60
    buffer_load_dwordx4 v[88:91], v14, s[32:35], s57 offen
    s_add_u32 s57, s57, 27648
    s_add_u32 s56, s56, 1
    buffer_load_dwordx4 v[92:95], v14, s[32:35], s57 offen
    s_cmp_eq_u32 s56, 40
    s_cselect_b32 s56, 0, s56
    v_mfma_f32_32x32x16_bf16 v[72:87], v[140:143], v[148:151], v[72:87]
    s_waitcnt lgkmcnt(2)
    v_mfma_f32_32x32x16_bf16 v[24:39], v[152:155], v[160:163], v[24:39]
    ds_read_b64_tr_b16 v[136:137], v19 offset:0
    ds_read_b64_tr_b16 v[138:139], v19 offset:256
    ds_read_b64_tr_b16 v[140:141], v19 offset:1088
    ds_read_b64_tr_b16 v[142:143], v19 offset:1344
    ds_read_b128 v[144:147], v8 offset:20480
    ds_read_b128 v[148:151], v15 offset:20480
    v_mfma_f32_32x32x16_bf16 v[40:55], v[152:155], v[164:167], v[40:55]
    s_waitcnt vmcnt(6)
    ds_write_b128 v21, v[112:115] offset:2176
    ds_write_b128 v21, v[116:119] offset:2688
    v_mfma_f32_32x32x16_bf16 v[56:71], v[156:159], v[160:163], v[56:71]
    s_mul_i32 s57, s56, 55296
    s_add_u32 s57, s57, s60
    buffer_load_dwordx4 v[96:99], v14, s[32:35], s57 offen
    s_add_u32 s57, s57, 27648
    s_add_u32 s56, s56, 1
    buffer_load_dwordx4 v[100:103], v14, s[32:35], s57 offen
    s_cmp_eq_u32 s56, 40
    s_cselect_b32 s56, 0, s56
    v_mfma_f32_32x32x16_bf16 v[72:87], v[156:159], v[164:167], v[72:87]
    s_waitcnt lgkmcnt(2)
    v_mfma_f32_32x32x16_bf16 v[24:39], v[136:139], v[144:147], v[24:39]
    ds_read_b64_tr_b16 v[152:153], v19 offset:2176
    ds_read_b64_tr_b16 v[154:155], v19 offset:2432
    ds_read_b64_tr_b16 v[156:157], v19 offset:3264
    ds_read_b64_tr_b16 v[158:159], v19 offset:3520
    ds_read_b128 v[160:163], v9 offset:21504
    ds_read_b128 v[164:167], v16 offset:21504
    v_mfma_f32_32x32x16_bf16 v[40:55], v[136:139], v[148:151], v[40:55]
    s_waitcnt vmcnt(6)
    ds_write_b128 v21, v[120:123] offset:0
    ds_write_b128 v21, v[124:127] offset:512
    v_mfma_f32_32x32x16_bf16 v[56:71], v[140:143], v[144:147], v[56:71]
    s_mul_i32 s57, s56, 55296
    s_add_u32 s57, s57, s60
    buffer_load_dwordx4 v[104:107], v14, s[32:35], s57 offen
    s_add_u32 s57, s57, 27648
    s_add_u32 s56, s56, 1
    buffer_load_dwordx4 v[108:111], v14, s[32:35], s57 offen
    s_cmp_eq_u32 s56, 40
    s_cselect_b32 s56, 0, s56
    v_mfma_f32_32x32x16_bf16 v[72:87], v[140:143], v[148:151], v[72:87]
    s_waitcnt lgkmcnt(2)
    v_mfma_f32_32x32x16_bf16 v[24:39], v[152:155], v[160:163], v[24:39]
    ds_read_b64_tr_b16 v[136:137], v19 offset:0
    ds_read_b64_tr_b16 v[138:139], v19 offset:256
    ds_read_b64_tr_b16 v[140:141], v19 offset:1088
    ds_read_b64_tr_b16 v[142:143], v19 offset:1344
    ds_read_b128 v[144:147], v10 offset:22528
    ds_read_b128 v[148:151], v17 offset:22528
    v_mfma_f32_32x32x16_bf16 v[40:55], v[152:155], v[164:167], v[40:55]
    s_waitcnt vmcnt(6)
    ds_write_b128 v21, v[128:131] offset:2176
    ds_write_b128 v21, v[132:135] offset:2688
    v_mfma_f32_32x32x16_bf16 v[56:71], v[156:159], v[160:163], v[56:71]
    s_mul_i32 s57, s56, 55296
    s_add_u32 s57, s57, s60
    buffer_load_dwordx4 v[112:115], v14, s[32:35], s57 offen
    s_add_u32 s57, s57, 27648
    s_add_u32 s56, s56, 1
    buffer_load_dwordx4 v[116:119], v14, s[32:35], s57 offen
    s_cmp_eq_u32 s56, 40
    s_cselect_b32 s56, 0, s56
    v_mfma_f32_32x32x16_bf16 v[72:87], v[156:159], v[164:167], v[72:87]
    s_waitcnt lgkmcnt(2)
    v_mfma_f32_32x32x16_bf16 v[24:39], v[136:139], v[144:147], v[24:39]
    ds_read_b64_tr_b16 v[152:153], v19 offset:2176
    ds_read_b64_tr_b16 v[154:155], v19 offset:2432
    ds_read_b64_tr_b16 v[156:157], v19 offset:3264
    ds_read_b64_tr_b16 v[158:159], v19 offset:3520
    ds_read_b128 v[160:163], v11 offset:23552
    ds_read_b128 v[164:167], v18 offset:23552
    v_mfma_f32_32x32x16_bf16 v[40:55], v[136:139], v[148:151], v[40:55]
    s_waitcnt vmcnt(6)
    ds_write_b128 v21, v[88:91] offset:0
    ds_write_b128 v21, v[92:95] offset:512
    v_mfma_f32_32x32x16_bf16 v[56:71], v[140:143], v[144:147], v[56:71]
    s_mul_i32 s57, s56, 55296
    s_add_u32 s57, s57, s60
    buffer_load_dwordx4 v[120:123], v14, s[32:35], s57 offen
    s_add_u32 s57, s57, 27648
    s_add_u32 s56, s56, 1
    buffer_load_dwordx4 v[124:127], v14, s[32:35], s57 offen
    s_cmp_eq_u32 s56, 40
    s_cselect_b32 s56, 0, s56
    v_mfma_f32_32x32x16_bf16 v[72:87], v[140:143], v[148:151], v[72:87]
    s_waitcnt lgkmcnt(2)
    v_mfma_f32_32x32x16_bf16 v[24:39], v[152:155], v[160:163], v[24:39]
    ds_read_b64_tr_b16 v[136:137], v19 offset:0
    ds_read_b64_tr_b16 v[138:139], v19 offset:256
    ds_read_b64_tr_b16 v[140:141], v19 offset:1088
    ds_read_b64_tr_b16 v[142:143], v19 offset:1344
    ds_read_b128 v[144:147], v8 offset:24576
    ds_read_b128 v[148:151], v15 offset:24576
    v_mfma_f32_32x32x16_bf16 v[40:55], v[152:155], v[164:167], v[40:55]
    s_waitcnt vmcnt(6)
    ds_write_b128 v21, v[96:99] offset:2176
    ds_write_b128 v21, v[100:103] offset:2688
    v_mfma_f32_32x32x16_bf16 v[56:71], v[156:159], v[160:163], v[56:71]
    s_mul_i32 s57, s56, 55296
    s_add_u32 s57, s57, s60
    buffer_load_dwordx4 v[128:131], v14, s[32:35], s57 offen
    s_add_u32 s57, s57, 27648
    s_add_u32 s56, s56, 1
    buffer_load_dwordx4 v[132:135], v14, s[32:35], s57 offen
    s_cmp_eq_u32 s56, 40
    s_cselect_b32 s56, 0, s56
    v_mfma_f32_32x32x16_bf16 v[72:87], v[156:159], v[164:167], v[72:87]
    s_waitcnt lgkmcnt(2)
    v_mfma_f32_32x32x16_bf16 v[24:39], v[136:139], v[144:147], v[24:39]
    ds_read_b64_tr_b16 v[152:153], v19 offset:2176
    ds_read_b64_tr_b16 v[154:155], v19 offset:2432
    ds_read_b64_tr_b16 v[156:157], v19 offset:3264
    ds_read_b64_tr_b16 v[158:159], v19 offset:3520
    ds_read_b128 v[160:163], v9 offset:25600
    ds_read_b128 v[164:167], v16 offset:25600
    v_mfma_f32_32x32x16_bf16 v[40:55], v[136:139], v[148:151], v[40:55]
    s_waitcnt vmcnt(6)
    ds_write_b128 v21, v[104:107] offset:0
    ds_write_b128 v21, v[108:111] offset:512
    v_mfma_f32_32x32x16_bf16 v[56:71], v[140:143], v[144:147], v[56:71]
    s_mul_i32 s57, s56, 55296
    s_add_u32 s57, s57, s60
    buffer_load_dwordx4 v[88:91], v14, s[32:35], s57 offen
    s_add_u32 s57, s57, 27648
    s_add_u32 s56, s56, 1
    buffer_load_dwordx4 v[92:95], v14, s[32:35], s57 offen
    s_cmp_eq_u32 s56, 40
    s_cselect_b32 s56, 0, s56
    v_mfma_f32_32x32x16_bf16 v[72:87], v[140:143], v[148:151], v[72:87]
    s_waitcnt lgkmcnt(2)
    v_mfma_f32_32x32x16_bf16 v[24:39], v[152:155], v[160:163], v[24:39]
    ds_read_b64_tr_b16 v[136:137], v19 offset:0
    ds_read_b64_tr_b16 v[138:139], v19 offset:256
    ds_read_b64_tr_b16 v[140:141], v19 offset:1088
    ds_read_b64_tr_b16 v[142:143], v19 offset:1344
    ds_read_b128 v[144:147], v10 offset:26624
    ds_read_b128 v[148:151], v17 offset:26624
    v_mfma_f32_32x32x16_bf16 v[40:55], v[152:155], v[164:167], v[40:55]
    s_waitcnt vmcnt(6)
    ds_write_b128 v21, v[112:115] offset:2176
    ds_write_b128 v21, v[116:119] offset:2688
    v_mfma_f32_32x32x16_bf16 v[56:71], v[156:159], v[160:163], v[56:71]
    s_mul_i32 s57, s56, 55296
    s_add_u32 s57, s57, s60
    buffer_load_dwordx4 v[96:99], v14, s[32:35], s57 offen
    s_add_u32 s57, s57, 27648
    s_add_u32 s56, s56, 1
    buffer_load_dwordx4 v[100:103], v14, s[32:35], s57 offen
    s_cmp_eq_u32 s56, 40
    s_cselect_b32 s56, 0, s56
    v_mfma_f32_32x32x16_bf16 v[72:87], v[156:159], v[164:167], v[72:87]
    s_waitcnt lgkmcnt(2)
    v_mfma_f32_32x32x16_bf16 v[24:39], v[136:139], v[144:147], v[24:39]
    ds_read_b64_tr_b16 v[152:153], v19 offset:2176
    ds_read_b64_tr_b16 v[154:155], v19 offset:2432
    ds_read_b64_tr_b16 v[156:157], v19 offset:3264
    ds_read_b64_tr_b16 v[158:159], v19 offset:3520
    ds_read_b128 v[160:163], v11 offset:27648
    ds_read_b128 v[164:167], v18 offset:27648
    v_mfma_f32_32x32x16_bf16 v[40:55], v[136:139], v[148:151], v[40:55]
    s_waitcnt vmcnt(6)
    ds_write_b128 v21, v[120:123] offset:0
    ds_write_b128 v21, v[124:127] offset:512
    v_mfma_f32_32x32x16_bf16 v[56:71], v[140:143], v[144:147], v[56:71]
    s_mul_i32 s57, s56, 55296
    s_add_u32 s57, s57, s60
    buffer_load_dwordx4 v[104:107], v14, s[32:35], s57 offen
    s_add_u32 s57, s57, 27648
    s_add_u32 s56, s56, 1
    buffer_load_dwordx4 v[108:111], v14, s[32:35], s57 offen
    s_cmp_eq_u32 s56, 40
    s_cselect_b32 s56, 0, s56
    v_mfma_f32_32x32x16_bf16 v[72:87], v[140:143], v[148:151], v[72:87]
    s_waitcnt lgkmcnt(2)
    v_mfma_f32_32x32x16_bf16 v[24:39], v[152:155], v[160:163], v[24:39]
    ds_read_b64_tr_b16 v[136:137], v19 offset:0
    ds_read_b64_tr_b16 v[138:139], v19 offset:256
    ds_read_b64_tr_b16 v[140:141], v19 offset:1088
    ds_read_b64_tr_b16 v[142:143], v19 offset:1344
    ds_read_b128 v[144:147], v8 offset:28672
    ds_read_b128 v[148:151], v15 offset:28672
    v_mfma_f32_32x32x16_bf16 v[40:55], v[152:155], v[164:167], v[40:55]
    s_waitcnt vmcnt(6)
    ds_write_b128 v21, v[128:131] offset:2176
    ds_write_b128 v21, v[132:135] offset:2688
    v_mfma_f32_32x32x16_bf16 v[56:71], v[156:159], v[160:163], v[56:71]
    s_mul_i32 s57, s56, 55296
    s_add_u32 s57, s57, s60
    buffer_load_dwordx4 v[112:115], v14, s[32:35], s57 offen
    s_add_u32 s57, s57, 27648
    s_add_u32 s56, s56, 1
    buffer_load_dwordx4 v[116:119], v14, s[32:35], s57 offen
    s_cmp_eq_u32 s56, 40
    s_cselect_b32 s56, 0, s56
    v_mfma_f32_32x32x16_bf16 v[72:87], v[156:159], v[164:167], v[72:87]
    s_waitcnt lgkmcnt(2)
    v_mfma_f32_32x32x16_bf16 v[24:39], v[136:139], v[144:147], v[24:39]
    ds_read_b64_tr_b16 v[152:153], v19 offset:2176
    ds_read_b64_tr_b16 v[154:155], v19 offset:2432
    ds_read_b64_tr_b16 v[156:157], v19 offset:3264
    ds_read_b64_tr_b16 v[158:159], v19 offset:3520
    ds_read_b128 v[160:163], v9 offset:29696
    ds_read_b128 v[164:167], v16 offset:29696
    v_mfma_f32_32x32x16_bf16 v[40:55], v[136:139], v[148:151], v[40:55]
    s_waitcnt vmcnt(6)
    ds_write_b128 v21, v[88:91] offset:0
    ds_write_b128 v21, v[92:95] offset:512
    v_mfma_f32_32x32x16_bf16 v[56:71], v[140:143], v[144:147], v[56:71]
    s_mul_i32 s57, s56, 55296
    s_add_u32 s57, s57, s60
    buffer_load_dwordx4 v[120:123], v14, s[32:35], s57 offen
    s_add_u32 s57, s57, 27648
    s_add_u32 s56, s56, 1
    buffer_load_dwordx4 v[124:127], v14, s[32:35], s57 offen
    s_cmp_eq_u32 s56, 40
    s_cselect_b32 s56, 0, s56
    v_mfma_f32_32x32x16_bf16 v[72:87], v[140:143], v[148:151], v[72:87]
    s_waitcnt lgkmcnt(2)
    v_mfma_f32_32x32x16_bf16 v[24:39], v[152:155], v[160:163], v[24:39]
    ds_read_b64_tr_b16 v[136:137], v19 offset:0
    ds_read_b64_tr_b16 v[138:139], v19 offset:256
    ds_read_b64_tr_b16 v[140:141], v19 offset:1088
    ds_read_b64_tr_b16 v[142:143], v19 offset:1344
    ds_read_b128 v[144:147], v10 offset:30720
    ds_read_b128 v[148:151], v17 offset:30720
    v_mfma_f32_32x32x16_bf16 v[40:55], v[152:155], v[164:167], v[40:55]
    s_waitcnt vmcnt(6)
    ds_write_b128 v21, v[96:99] offset:2176
    ds_write_b128 v21, v[100:103] offset:2688
    v_mfma_f32_32x32x16_bf16 v[56:71], v[156:159], v[160:163], v[56:71]
    s_mul_i32 s57, s56, 55296
    s_add_u32 s57, s57, s60
    buffer_load_dwordx4 v[128:131], v14, s[32:35], s57 offen
    s_add_u32 s57, s57, 27648
    s_add_u32 s56, s56, 1
    buffer_load_dwordx4 v[132:135], v14, s[32:35], s57 offen
    s_cmp_eq_u32 s56, 40
    s_cselect_b32 s56, 0, s56
    v_mfma_f32_32x32x16_bf16 v[72:87], v[156:159], v[164:167], v[72:87]
    s_waitcnt lgkmcnt(2)
    v_mfma_f32_32x32x16_bf16 v[24:39], v[136:139], v[144:147], v[24:39]
    ds_read_b64_tr_b16 v[152:153], v19 offset:2176
    ds_read_b64_tr_b16 v[154:155], v19 offset:2432
    ds_read_b64_tr_b16 v[156:157], v19 offset:3264
    ds_read_b64_tr_b16 v[158:159], v19 offset:3520
    ds_read_b128 v[160:163], v11 offset:31744
    ds_read_b128 v[164:167], v18 offset:31744
    v_mfma_f32_32x32x16_bf16 v[40:55], v[136:139], v[148:151], v[40:55]
    s_waitcnt vmcnt(6)
    ds_write_b128 v21, v[104:107] offset:0
    ds_write_b128 v21, v[108:111] offset:512
    v_mfma_f32_32x32x16_bf16 v[56:71], v[140:143], v[144:147], v[56:71]
    s_mul_i32 s57, s56, 55296
    s_add_u32 s57, s57, s60
    buffer_load_dwordx4 v[88:91], v14, s[32:35], s57 offen
    s_add_u32 s57, s57, 27648
    s_add_u32 s56, s56, 1
    buffer_load_dwordx4 v[92:95], v14, s[32:35], s57 offen
    s_cmp_eq_u32 s56, 40
    s_cselect_b32 s56, 0, s56
    v_mfma_f32_32x32x16_bf16 v[72:87], v[140:143], v[148:151], v[72:87]
    s_waitcnt lgkmcnt(2)
    v_mfma_f32_32x32x16_bf16 v[24:39], v[152:155], v[160:163], v[24:39]
    ds_read_b64_tr_b16 v[136:137], v19 offset:0
    ds_read_b64_tr_b16 v[138:139], v19 offset:256
    ds_read_b64_tr_b16 v[140:141], v19 offset:1088
    ds_read_b64_tr_b16 v[142:143], v19 offset:1344
    ds_read_b128 v[144:147], v8 offset:32768
    ds_read_b128 v[148:151], v15 offset:32768
    v_mfma_f32_32x32x16_bf16 v[40:55], v[152:155], v[164:167], v[40:55]
    s_waitcnt vmcnt(6)
    ds_write_b128 v21, v[112:115] offset:2176
    ds_write_b128 v21, v[116:119] offset:2688
    v_mfma_f32_32x32x16_bf16 v[56:71], v[156:159], v[160:163], v[56:71]
    s_mul_i32 s57, s56, 55296
    s_add_u32 s57, s57, s60
    buffer_load_dwordx4 v[96:99], v14, s[32:35], s57 offen
    s_add_u32 s57, s57, 27648
    s_add_u32 s56, s56, 1
    buffer_load_dwordx4 v[100:103], v14, s[32:35], s57 offen
    s_cmp_eq_u32 s56, 40
    s_cselect_b32 s56, 0, s56
    v_mfma_f32_32x32x16_bf16 v[72:87], v[156:159], v[164:167], v[72:87]
    s_waitcnt lgkmcnt(2)
    v_mfma_f32_32x32x16_bf16 v[24:39], v[136:139], v[144:147], v[24:39]
    ds_read_b64_tr_b16 v[152:153], v19 offset:2176
    ds_read_b64_tr_b16 v[154:155], v19 offset:2432
    ds_read_b64_tr_b16 v[156:157], v19 offset:3264
    ds_read_b64_tr_b16 v[158:159], v19 offset:3520
    ds_read_b128 v[160:163], v9 offset:33792
    ds_read_b128 v[164:167], v16 offset:33792
    v_mfma_f32_32x32x16_bf16 v[40:55], v[136:139], v[148:151], v[40:55]
    s_waitcnt vmcnt(6)
    ds_write_b128 v21, v[120:123] offset:0
    ds_write_b128 v21, v[124:127] offset:512
    v_mfma_f32_32x32x16_bf16 v[56:71], v[140:143], v[144:147], v[56:71]
    s_mul_i32 s57, s56, 55296
    s_add_u32 s57, s57, s60
    buffer_load_dwordx4 v[104:107], v14, s[32:35], s57 offen
    s_add_u32 s57, s57, 27648
    s_add_u32 s56, s56, 1
    buffer_load_dwordx4 v[108:111], v14, s[32:35], s57 offen
    s_cmp_eq_u32 s56, 40
    s_cselect_b32 s56, 0, s56
    v_mfma_f32_32x32x16_bf16 v[72:87], v[140:143], v[148:151], v[72:87]
    s_waitcnt lgkmcnt(2)
    v_mfma_f32_32x32x16_bf16 v[24:39], v[152:155], v[160:163], v[24:39]
    ds_read_b64_tr_b16 v[136:137], v19 offset:0
    ds_read_b64_tr_b16 v[138:139], v19 offset:256
    ds_read_b64_tr_b16 v[140:141], v19 offset:1088
    ds_read_b64_tr_b16 v[142:143], v19 offset:1344
    ds_read_b128 v[144:147], v10 offset:34816
    ds_read_b128 v[148:151], v17 offset:34816
    v_mfma_f32_32x32x16_bf16 v[40:55], v[152:155], v[164:167], v[40:55]
    s_waitcnt vmcnt(6)
    ds_write_b128 v21, v[128:131] offset:2176
    ds_write_b128 v21, v[132:135] offset:2688
    v_mfma_f32_32x32x16_bf16 v[56:71], v[156:159], v[160:163], v[56:71]
    s_mul_i32 s57, s56, 55296
    s_add_u32 s57, s57, s60
    buffer_load_dwordx4 v[112:115], v14, s[32:35], s57 offen
    s_add_u32 s57, s57, 27648
    s_add_u32 s56, s56, 1
    buffer_load_dwordx4 v[116:119], v14, s[32:35], s57 offen
    s_cmp_eq_u32 s56, 40
    s_cselect_b32 s56, 0, s56
    v_mfma_f32_32x32x16_bf16 v[72:87], v[156:159], v[164:167], v[72:87]
    s_waitcnt lgkmcnt(2)
    v_mfma_f32_32x32x16_bf16 v[24:39], v[136:139], v[144:147], v[24:39]
    ds_read_b64_tr_b16 v[152:153], v19 offset:2176
    ds_read_b64_tr_b16 v[154:155], v19 offset:2432
    ds_read_b64_tr_b16 v[156:157], v19 offset:3264
    ds_read_b64_tr_b16 v[158:159], v19 offset:3520
    ds_read_b128 v[160:163], v11 offset:35840
    ds_read_b128 v[164:167], v18 offset:35840
    v_mfma_f32_32x32x16_bf16 v[40:55], v[136:139], v[148:151], v[40:55]
    s_waitcnt vmcnt(6)
    ds_write_b128 v21, v[88:91] offset:0
    ds_write_b128 v21, v[92:95] offset:512
    v_mfma_f32_32x32x16_bf16 v[56:71], v[140:143], v[144:147], v[56:71]
    v_mfma_f32_32x32x16_bf16 v[72:87], v[140:143], v[148:151], v[72:87]
    s_setprio 3
    v_mov_b32 v14, 1
    v_and_b32 v4, 63, v1
    v_lshlrev_b32 v4, 7, v4
    s_setprio 0
    s_lshl_b32 s56, s61, 13
    s_add_u32 s56, s56, 21037056
    s_waitcnt lgkmcnt(2)
    v_mfma_f32_32x32x16_bf16 v[24:39], v[152:155], v[160:163], v[24:39]
    ds_read_b64_tr_b16 v[136:137], v19 offset:0
    ds_read_b64_tr_b16 v[138:139], v19 offset:256
    ds_read_b64_tr_b16 v[140:141], v19 offset:1088
    ds_read_b64_tr_b16 v[142:143], v19 offset:1344
    ds_read_b128 v[144:147], v8 offset:36864
    ds_read_b128 v[148:151], v15 offset:36864
    v_mfma_f32_32x32x16_bf16 v[40:55], v[152:155], v[164:167], v[40:55]
    s_waitcnt vmcnt(4)
    ds_write_b128 v21, v[96:99] offset:2176
    ds_write_b128 v21, v[100:103] offset:2688
    v_mfma_f32_32x32x16_bf16 v[56:71], v[156:159], v[160:163], v[56:71]
    v_mfma_f32_32x32x16_bf16 v[72:87], v[156:159], v[164:167], v[72:87]
    s_waitcnt lgkmcnt(2)
    v_mfma_f32_32x32x16_bf16 v[24:39], v[136:139], v[144:147], v[24:39]
    ds_read_b64_tr_b16 v[152:153], v19 offset:2176
    ds_read_b64_tr_b16 v[154:155], v19 offset:2432
    ds_read_b64_tr_b16 v[156:157], v19 offset:3264
    ds_read_b64_tr_b16 v[158:159], v19 offset:3520
    ds_read_b128 v[160:163], v9 offset:37888
    ds_read_b128 v[164:167], v16 offset:37888
    v_mfma_f32_32x32x16_bf16 v[40:55], v[136:139], v[148:151], v[40:55]
    s_waitcnt vmcnt(2)
    ds_write_b128 v21, v[104:107] offset:0
    ds_write_b128 v21, v[108:111] offset:512
    v_mfma_f32_32x32x16_bf16 v[56:71], v[140:143], v[144:147], v[56:71]
    v_mfma_f32_32x32x16_bf16 v[72:87], v[140:143], v[148:151], v[72:87]
    s_waitcnt lgkmcnt(2)
    v_mfma_f32_32x32x16_bf16 v[24:39], v[152:155], v[160:163], v[24:39]
    ds_read_b64_tr_b16 v[136:137], v19 offset:0
    ds_read_b64_tr_b16 v[138:139], v19 offset:256
    ds_read_b64_tr_b16 v[140:141], v19 offset:1088
    ds_read_b64_tr_b16 v[142:143], v19 offset:1344
    ds_read_b128 v[144:147], v10 offset:38912
    ds_read_b128 v[148:151], v17 offset:38912
    v_mfma_f32_32x32x16_bf16 v[40:55], v[152:155], v[164:167], v[40:55]
    s_waitcnt vmcnt(0)
    ds_write_b128 v21, v[112:115] offset:2176
    ds_write_b128 v21, v[116:119] offset:2688
    v_mfma_f32_32x32x16_bf16 v[56:71], v[156:159], v[160:163], v[56:71]
    v_mfma_f32_32x32x16_bf16 v[72:87], v[156:159], v[164:167], v[72:87]
    buffer_load_dwordx2 v[2:3], v4, s[44:47], s56 offen sc1
    s_waitcnt lgkmcnt(2)
    v_mfma_f32_32x32x16_bf16 v[24:39], v[136:139], v[144:147], v[24:39]
    ds_read_b64_tr_b16 v[152:153], v19 offset:2176
    ds_read_b64_tr_b16 v[154:155], v19 offset:2432
    ds_read_b64_tr_b16 v[156:157], v19 offset:3264
    ds_read_b64_tr_b16 v[158:159], v19 offset:3520
    ds_read_b128 v[160:163], v11 offset:39936
    ds_read_b128 v[164:167], v18 offset:39936
    ds_add_u32 v13, v14 offset:280
    v_mfma_f32_32x32x16_bf16 v[40:55], v[136:139], v[148:151], v[40:55]
    v_mfma_f32_32x32x16_bf16 v[56:71], v[140:143], v[144:147], v[56:71]
    v_mfma_f32_32x32x16_bf16 v[72:87], v[140:143], v[148:151], v[72:87]
    s_waitcnt lgkmcnt(1)
    v_mfma_f32_32x32x16_bf16 v[24:39], v[152:155], v[160:163], v[24:39]
    v_mfma_f32_32x32x16_bf16 v[40:55], v[152:155], v[164:167], v[40:55]
    v_mfma_f32_32x32x16_bf16 v[56:71], v[156:159], v[160:163], v[56:71]
    v_mfma_f32_32x32x16_bf16 v[72:87], v[156:159], v[164:167], v[72:87]
    s_setprio 3
    s_waitcnt vmcnt(0)
    v_cmp_ne_u64 vcc, s[30:31], v[2:3]
    s_nop 1
    s_cmp_eq_u64 vcc, 0
    s_cbranch_scc1 G_WPOK
    s_mov_b32 s63, 200000
POLL_89:
    buffer_load_dwordx2 v[2:3], v4, s[44:47], s56 offen sc1
    s_waitcnt vmcnt(0)
    v_cmp_ne_u64 vcc, s[30:31], v[2:3]
    s_nop 1
    s_cmp_eq_u64 vcc, 0
    s_cbranch_scc1 POLLD_90
    s_sleep 8
    s_sub_u32 s63, s63, 1
    s_cmp_lg_u32 s63, 0
    s_cbranch_scc1 POLL_89
POLLD_90:
G_WPOK:
    v_mov_b32 v2, 256
    ds_add_u32 v13, v2 offset:280
    s_lshl_b32 s52, s48, 1
    s_mul_i32 s52, s52, 108
    s_lshl_b32 s53, s54, 2
    s_add_u32 s52, s52, s53
    s_lshl_b32 s52, s52, 10
    s_add_u32 s52, s52, 3145728
    s_add_u32 s53, s52, 110592
    v_max_f32 v24, 0, v24
    v_max_f32 v25, 0, v25
    v_max_f32 v26, 0, v26
    v_max_f32 v27, 0, v27
    v_max_f32 v28, 0, v28
    v_max_f32 v29, 0, v29
    v_max_f32 v30, 0, v30
    v_max_f32 v31, 0, v31
    v_pk_mul_f32 v[24:25], v[24:25], v[24:25]
    v_pk_mul_f32 v[26:27], v[26:27], v[26:27]
    v_pk_mul_f32 v[28:29], v[28:29], v[28:29]
    v_pk_mul_f32 v[30:31], v[30:31], v[30:31]
    v_cvt_pk_bf16_f32 v136, v24, v25
    v_cvt_pk_bf16_f32 v137, v26, v27
    v_cvt_pk_bf16_f32 v138, v28, v29
    v_cvt_pk_bf16_f32 v139, v30, v31
    buffer_store_dwordx4 v[136:139], v22, s[44:47], s52 offen offset:0 sc1
    v_max_f32 v40, 0, v40
    v_max_f32 v41, 0, v41
    v_max_f32 v42, 0, v42
    v_max_f32 v43, 0, v43
    v_max_f32 v44, 0, v44
    v_max_f32 v45, 0, v45
    v_max_f32 v46, 0, v46
    v_max_f32 v47, 0, v47
    v_pk_mul_f32 v[40:41], v[40:41], v[40:41]
    v_pk_mul_f32 v[42:43], v[42:43], v[42:43]
    v_pk_mul_f32 v[44:45], v[44:45], v[44:45]
    v_pk_mul_f32 v[46:47], v[46:47], v[46:47]
    v_cvt_pk_bf16_f32 v140, v40, v41
    v_cvt_pk_bf16_f32 v141, v42, v43
    v_cvt_pk_bf16_f32 v142, v44, v45
    v_cvt_pk_bf16_f32 v143, v46, v47
    buffer_store_dwordx4 v[140:143], v22, s[44:47], s53 offen offset:0 sc1
    v_max_f32 v32, 0, v32
    v_max_f32 v33, 0, v33
    v_max_f32 v34, 0, v34
    v_max_f32 v35, 0, v35
    v_max_f32 v36, 0, v36
    v_max_f32 v37, 0, v37
    v_max_f32 v38, 0, v38
    v_max_f32 v39, 0, v39
    v_pk_mul_f32 v[32:33], v[32:33], v[32:33]
    v_pk_mul_f32 v[34:35], v[34:35], v[34:35]
    v_pk_mul_f32 v[36:37], v[36:37], v[36:37]
    v_pk_mul_f32 v[38:39], v[38:39], v[38:39]
    v_cvt_pk_bf16_f32 v144, v32, v33
    v_cvt_pk_bf16_f32 v145, v34, v35
    v_cvt_pk_bf16_f32 v146, v36, v37
    v_cvt_pk_bf16_f32 v147, v38, v39
    buffer_store_dwordx4 v[144:147], v22, s[44:47], s52 offen offset:1024 sc1
    v_max_f32 v48, 0, v48
    v_max_f32 v49, 0, v49
    v_max_f32 v50, 0, v50
    v_max_f32 v51, 0, v51
    v_max_f32 v52, 0, v52
    v_max_f32 v53, 0, v53
    v_max_f32 v54, 0, v54
    v_max_f32 v55, 0, v55
    v_pk_mul_f32 v[48:49], v[48:49], v[48:49]
    v_pk_mul_f32 v[50:51], v[50:51], v[50:51]
    v_pk_mul_f32 v[52:53], v[52:53], v[52:53]
    v_pk_mul_f32 v[54:55], v[54:55], v[54:55]
    v_cvt_pk_bf16_f32 v148, v48, v49
    v_cvt_pk_bf16_f32 v149, v50, v51
    v_cvt_pk_bf16_f32 v150, v52, v53
    v_cvt_pk_bf16_f32 v151, v54, v55
    buffer_store_dwordx4 v[148:151], v22, s[44:47], s53 offen offset:1024 sc1
    v_max_f32 v56, 0, v56
    v_max_f32 v57, 0, v57
    v_max_f32 v58, 0, v58
    v_max_f32 v59, 0, v59
    v_max_f32 v60, 0, v60
    v_max_f32 v61, 0, v61
    v_max_f32 v62, 0, v62
    v_max_f32 v63, 0, v63
    v_pk_mul_f32 v[56:57], v[56:57], v[56:57]
    v_pk_mul_f32 v[58:59], v[58:59], v[58:59]
    v_pk_mul_f32 v[60:61], v[60:61], v[60:61]
    v_pk_mul_f32 v[62:63], v[62:63], v[62:63]
    v_cvt_pk_bf16_f32 v152, v56, v57
    v_cvt_pk_bf16_f32 v153, v58, v59
    v_cvt_pk_bf16_f32 v154, v60, v61
    v_cvt_pk_bf16_f32 v155, v62, v63
    buffer_store_dwordx4 v[152:155], v22, s[44:47], s52 offen offset:2048 sc1
    v_max_f32 v72, 0, v72
    v_max_f32 v73, 0, v73
    v_max_f32 v74, 0, v74
    v_max_f32 v75, 0, v75
    v_max_f32 v76, 0, v76
    v_max_f32 v77, 0, v77
    v_max_f32 v78, 0, v78
    v_max_f32 v79, 0, v79
    v_pk_mul_f32 v[72:73], v[72:73], v[72:73]
    v_pk_mul_f32 v[74:75], v[74:75], v[74:75]
    v_pk_mul_f32 v[76:77], v[76:77], v[76:77]
    v_pk_mul_f32 v[78:79], v[78:79], v[78:79]
    v_cvt_pk_bf16_f32 v156, v72, v73
    v_cvt_pk_bf16_f32 v157, v74, v75
    v_cvt_pk_bf16_f32 v158, v76, v77
    v_cvt_pk_bf16_f32 v159, v78, v79
    buffer_store_dwordx4 v[156:159], v22, s[44:47], s53 offen offset:2048 sc1
    v_max_f32 v64, 0, v64
    v_max_f32 v65, 0, v65
    v_max_f32 v66, 0, v66
    v_max_f32 v67, 0, v67
    v_max_f32 v68, 0, v68
    v_max_f32 v69, 0, v69
    v_max_f32 v70, 0, v70
    v_max_f32 v71, 0, v71
    v_pk_mul_f32 v[64:65], v[64:65], v[64:65]
    v_pk_mul_f32 v[66:67], v[66:67], v[66:67]
    v_pk_mul_f32 v[68:69], v[68:69], v[68:69]
    v_pk_mul_f32 v[70:71], v[70:71], v[70:71]
    v_cvt_pk_bf16_f32 v160, v64, v65
    v_cvt_pk_bf16_f32 v161, v66, v67
    v_cvt_pk_bf16_f32 v162, v68, v69
    v_cvt_pk_bf16_f32 v163, v70, v71
    buffer_store_dwordx4 v[160:163], v22, s[44:47], s52 offen offset:3072 sc1
    v_max_f32 v80, 0, v80
    v_max_f32 v81, 0, v81
    v_max_f32 v82, 0, v82
    v_max_f32 v83, 0, v83
    v_max_f32 v84, 0, v84
    v_max_f32 v85, 0, v85
    v_max_f32 v86, 0, v86
    v_max_f32 v87, 0, v87
    v_pk_mul_f32 v[80:81], v[80:81], v[80:81]
    v_pk_mul_f32 v[82:83], v[82:83], v[82:83]
    v_pk_mul_f32 v[84:85], v[84:85], v[84:85]
    v_pk_mul_f32 v[86:87], v[86:87], v[86:87]
    v_cvt_pk_bf16_f32 v164, v80, v81
    v_cvt_pk_bf16_f32 v165, v82, v83
    v_cvt_pk_bf16_f32 v166, v84, v85
    v_cvt_pk_bf16_f32 v167, v86, v87
    buffer_store_dwordx4 v[164:167], v22, s[44:47], s53 offen offset:3072 sc1
G_F1DONE:
    s_setprio 3
    s_mov_b32 s15, s58
    s_mul_i32 s54, s61, 25600
    s_add_u32 s54, s54, 45056
    v_bfe_u32 v2, v1, 2, 2
    v_lshlrev_b32 v2, 1, v2
    v_lshl_add_u32 v2, v7, 3, v2
    v_bfe_u32 v3, v1, 4, 1
    v_and_b32 v5, 3, v1
    v_lshl_add_u32 v3, v3, 2, v5
    v_mul_u32_u24 v2, 160, v2
    v_add_u32 v2, s54, v2
    v_and_b32 v4, 1, v3
    v_lshrrev_b32 v3, 1, v3
    v_lshl_add_u32 v5, v4, 2, v3
    v_lshl_add_u32 v5, v5, 3, v2
    s_and_b32 s52, s61, 1
    s_lshl_b32 s53, s52, 6
    v_add_u32 v19, s53, v5
    s_xor_b32 s53, s53, 64
    v_add_u32 v20, s53, v5
    v_xor_b32 v3, s52, v3
    v_lshl_add_u32 v5, v3, 1, v4
    v_lshl_add_u32 v5, v5, 3, v2
    v_and_b32 v3, 16, v1
    v_lshl_add_u32 v5, v3, 16, v5
    v_add_u32 v21, 128, v5
    s_mul_i32 s59, s61, 14
    s_cmp_eq_u32 s61, 3
    s_cselect_b32 s60, 6, 8
    s_cselect_b32 s62, 0x8000, 6
    s_add_u32 s53, s51, 0
    s_and_b32 s52, s53, 3
    s_add_u32 s64, s59, s52
    s_bitcmp1_b32 s53, 2
    s_cselect_b32 s52, s60, 0
    s_add_u32 s64, s64, s52
    s_add_u32 s53, s51, 1
    s_and_b32 s52, s53, 3
    s_add_u32 s65, s59, s52
    s_bitcmp1_b32 s53, 2
    s_cselect_b32 s52, s60, 0
    s_add_u32 s65, s65, s52
    s_add_u32 s53, s51, 2
    s_and_b32 s52, s53, 3
    s_add_u32 s66, s59, s52
    s_bitcmp1_b32 s53, 2
    s_cselect_b32 s52, s60, 0
    s_add_u32 s66, s66, s52
    s_add_u32 s53, s51, 3
    s_and_b32 s52, s53, 3
    s_add_u32 s67, s59, s52
    s_bitcmp1_b32 s53, 2
    s_cselect_b32 s52, s60, 0
    s_add_u32 s67, s67, s52
    s_add_u32 s53, s51, 4
    s_and_b32 s52, s53, 3
    s_add_u32 s68, s59, s52
    s_bitcmp1_b32 s53, 2
    s_cselect_b32 s52, s60, 0
    s_add_u32 s68, s68, s52
    s_add_u32 s53, s51, 5
    s_and_b32 s52, s53, 3
    s_add_u32 s69, s59, s52
    s_bitcmp1_b32 s53, 2
    s_cselect_b32 s52, s60, 0
    s_add_u32 s69, s69, s52
    s_add_u32 s53, s51, 6
    s_and_b32 s52, s53, 3
    s_add_u32 s70, s59, s52
    s_bitcmp1_b32 s53, 2
    s_cselect_b32 s52, s60, 0
    s_add_u32 s70, s70, s52
    s_add_u32 s53, s51, 7
    s_and_b32 s52, s53, 3
    s_add_u32 s71, s59, s52
    s_bitcmp1_b32 s53, 2
    s_cselect_b32 s52, s60, 0
    s_add_u32 s71, s71, s52
    s_cmp_ge_u32 s51, 6
    s_cselect_b32 s53, 6, 0
    s_sub_u32 s53, s51, s53
    s_add_u32 s60, s60, 4
    s_cmp_lt_u32 s53, 2
    s_cselect_b32 s52, 4, s60
    s_cmp_ge_u32 s53, 4
    s_cselect_b32 s52, s62, s52
    s_add_u32 s72, s59, s52
    s_and_b32 s52, s53, 1
    s_add_u32 s72, s72, s52
    s_add_u32 s53, s53, 1
    s_cmp_eq_u32 s53, 6
    s_cselect_b32 s53, 0, s53
    s_cmp_lt_u32 s53, 2
    s_cselect_b32 s52, 4, s60
    s_cmp_ge_u32 s53, 4
    s_cselect_b32 s52, s62, s52
    s_add_u32 s73, s59, s52
    s_and_b32 s52, s53, 1
    s_add_u32 s73, s73, s52
    s_add_u32 s53, s53, 1
    s_cmp_eq_u32 s53, 6
    s_cselect_b32 s53, 0, s53
    s_cmp_lt_u32 s53, 2
    s_cselect_b32 s52, 4, s60
    s_cmp_ge_u32 s53, 4
    s_cselect_b32 s52, s62, s52
    s_add_u32 s74, s59, s52
    s_and_b32 s52, s53, 1
    s_add_u32 s74, s74, s52
    s_add_u32 s53, s53, 1
    s_cmp_eq_u32 s53, 6
    s_cselect_b32 s53, 0, s53
    s_cmp_lt_u32 s53, 2
    s_cselect_b32 s52, 4, s60
    s_cmp_ge_u32 s53, 4
    s_cselect_b32 s52, s62, s52
    s_add_u32 s75, s59, s52
    s_and_b32 s52, s53, 1
    s_add_u32 s75, s75, s52
    s_add_u32 s53, s53, 1
    s_cmp_eq_u32 s53, 6
    s_cselect_b32 s53, 0, s53
    s_cmp_lt_u32 s53, 2
    s_cselect_b32 s52, 4, s60
    s_cmp_ge_u32 s53, 4
    s_cselect_b32 s52, s62, s52
    s_add_u32 s76, s59, s52
    s_and_b32 s52, s53, 1
    s_add_u32 s76, s76, s52
    s_add_u32 s53, s53, 1
    s_cmp_eq_u32 s53, 6
    s_cselect_b32 s53, 0, s53
    s_cmp_lt_u32 s53, 2
    s_cselect_b32 s52, 4, s60
    s_cmp_ge_u32 s53, 4
    s_cselect_b32 s52, s62, s52
    s_add_u32 s77, s59, s52
    s_and_b32 s52, s53, 1
    s_add_u32 s77, s77, s52
    s_mul_i32 s59, s49, 378880
    s_add_u32 s59, s59, 10485760
    s_lshl_b32 s57, s48, 1
    s_lshr_b32 s52, s61, 1
    s_add_u32 s57, s57, s52
    s_mul_i32 s57, s57, 110592
    s_add_u32 s57, s57, 3145728
    s_cmp_lt_u32 s61, 2
    s_mov_b32 s14, 4294856704
    s_cmov_b32 s14, 110592
    s_lshl_b32 s58, s48, 12
    s_lshl_b32 s52, s61, 10
    s_add_u32 s58, s58, s52
    s_add_u32 s58, s58, 21102592
    v_and_b32 v23, 7, v1
    v_lshlrev_b32 v23, 7, v23
    s_waitcnt vmcnt(0)
    v_mov_b32 v2, s30
    v_mov_b32 v3, s31
    v_lshlrev_b32 v4, 3, v1
    s_mov_b64 exec, 0xffff
    buffer_store_dwordx2 v[2:3], v4, s[44:47], s15 offen sc1
    s_mov_b64 exec, -1
    buffer_load_dwordx2 v[164:165], v23, s[44:47], s58 offen sc1
    s_mov_b32 s63, 1600000
LW_91:
    ds_read_b32 v2, v12 offset:280
    s_waitcnt lgkmcnt(0)
    v_readfirstlane_b32 s52, v2
    s_nop 1
    s_cmp_ge_u32 s52, 1028
    s_cbranch_scc1 LWD_92
    s_sleep 2
    s_sub_u32 s63, s63, 1
    s_cmp_lg_u32 s63, 0
    s_cbranch_scc1 LW_91
LWD_92:
    s_mov_b32 s63, 1600000
LW_93:
    ds_read_b32 v2, v12 offset:272
    s_waitcnt lgkmcnt(0)
    v_readfirstlane_b32 s52, v2
    s_nop 1
    s_cmp_ge_u32 s52, 2008
    s_cbranch_scc1 LWD_94
    s_sleep 1
    s_sub_u32 s63, s63, 1
    s_cmp_lg_u32 s63, 0
    s_cbranch_scc1 LW_93
LWD_94:
    s_mul_i32 s55, s64, 5120
    s_add_u32 s55, s55, s59
    s_add_u32 m0, s54, 0
    s_nop 0
    buffer_load_dwordx4 v22, s[44:47], s55 offen offset:0 sc1 lds
    buffer_load_dwordx4 v22, s[44:47], s55 offen offset:1024 sc1 lds
    buffer_load_dwordx4 v22, s[44:47], s55 offen offset:2048 sc1 lds
    buffer_load_dwordx4 v22, s[44:47], s55 offen offset:3072 sc1 lds
    s_add_u32 m0, s54, 4096
    s_add_u32 s55, s55, 4096
    buffer_load_dwordx4 v22, s[44:47], s55 offen sc1 lds
    s_mul_i32 s55, s65, 5120
    s_add_u32 s55, s55, s59
    s_add_u32 m0, s54, 5120
    s_nop 0
    buffer_load_dwordx4 v22, s[44:47], s55 offen offset:0 sc1 lds
    buffer_load_dwordx4 v22, s[44:47], s55 offen offset:1024 sc1 lds
    buffer_load_dwordx4 v22, s[44:47], s55 offen offset:2048 sc1 lds
    buffer_load_dwordx4 v22, s[44:47], s55 offen offset:3072 sc1 lds
    s_add_u32 m0, s54, 9216
    s_add_u32 s55, s55, 4096
    buffer_load_dwordx4 v22, s[44:47], s55 offen sc1 lds
    s_mul_i32 s55, s66, 5120
    s_add_u32 s55, s55, s59
    s_add_u32 m0, s54, 10240
    s_nop 0
    buffer_load_dwordx4 v22, s[44:47], s55 offen offset:0 sc1 lds
    buffer_load_dwordx4 v22, s[44:47], s55 offen offset:1024 sc1 lds
    buffer_load_dwordx4 v22, s[44:47], s55 offen offset:2048 sc1 lds
    buffer_load_dwordx4 v22, s[44:47], s55 offen offset:3072 sc1 lds
    s_add_u32 m0, s54, 14336
    s_add_u32 s55, s55, 4096
    buffer_load_dwordx4 v22, s[44:47], s55 offen sc1 lds
    s_waitcnt vmcnt(15)
    v_cmp_ne_u64 vcc, s[30:31], v[164:165]
    s_nop 1
    s_and_b32 s52, vcc_lo, 51
    s_cmp_eq_u32 s52, 0
    s_cbranch_scc1 G_F2G
    s_mov_b32 s63, 200000
POLL_95:
    buffer_load_dwordx2 v[164:165], v23, s[44:47], s58 offen sc1
    s_waitcnt vmcnt(0)
    v_cmp_ne_u64 vcc, s[30:31], v[164:165]
    s_nop 1
    s_and_b32 s52, vcc_lo, 51
    s_cmp_eq_u32 s52, 0
    s_cbranch_scc1 POLLD_96
    s_sleep 8
    s_sub_u32 s63, s63, 1
    s_cmp_lg_u32 s63, 0
    s_cbranch_scc1 POLL_95
POLLD_96:
G_F2G:
    s_lshl_b32 s56, s64, 11
    s_add_u32 s56, s56, s57
    s_add_u32 s52, s56, s14
    buffer_load_dwordx4 v[120:123], v22, s[44:47], s56 offen offset:0 sc1
    buffer_load_dwordx4 v[124:127], v22, s[44:47], s52 offen offset:0 sc1
    s_lshl_b32 s56, s64, 11
    s_add_u32 s56, s56, s57
    s_add_u32 s52, s56, s14
    buffer_load_dwordx4 v[128:131], v22, s[44:47], s56 offen offset:1024 sc1
    buffer_load_dwordx4 v[132:135], v22, s[44:47], s52 offen offset:1024 sc1
    s_lshl_b32 s56, s65, 11
    s_add_u32 s56, s56, s57
    s_add_u32 s52, s56, s14
    buffer_load_dwordx4 v[136:139], v22, s[44:47], s56 offen offset:0 sc1
    buffer_load_dwordx4 v[140:143], v22, s[44:47], s52 offen offset:0 sc1
    s_lshl_b32 s52, s2, 4
    s_add_u32 s52, s52, s50
    s_cmp_lg_u32 s52, 8
    s_cbranch_scc1 G_NOEP
    s_mov_b32 s55, 21495808
    v_mov_b32 v2, s30
    v_mov_b32 v3, s31
    v_lshlrev_b32 v4, 3, v1
    s_mov_b64 exec, 0xffff
    buffer_store_dwordx2 v[2:3], v4, s[44:47], s55 offen sc1
    s_mov_b64 exec, -1
G_NOEP:
    s_setprio 0
    s_waitcnt vmcnt(16) lgkmcnt(0)
    ds_read_b64_tr_b16 v[152:153], v19 offset:0
    ds_read_b64_tr_b16 v[154:155], v19 offset:160
    ds_read_b64_tr_b16 v[156:157], v20 offset:0
    ds_read_b64_tr_b16 v[158:159], v20 offset:160
    ds_read_b64_tr_b16 v[160:161], v21 offset:0
    ds_read_b64_tr_b16 v[162:163], v21 offset:160
    s_lshl_b32 s56, s65, 11
    s_add_u32 s56, s56, s57
    s_add_u32 s52, s56, s14
    buffer_load_dwordx4 v[144:147], v22, s[44:47], s56 offen offset:1024 sc1
    buffer_load_dwordx4 v[148:151], v22, s[44:47], s52 offen offset:1024 sc1
    s_waitcnt vmcnt(6)
    s_waitcnt lgkmcnt(4)
    v_mfma_f32_32x32x16_bf16 v[24:39], v[152:155], v[120:123], 0
    s_mul_i32 s55, s67, 5120
    s_add_u32 s55, s55, s59
    s_add_u32 m0, s54, 15360
    s_nop 0
    buffer_load_dwordx4 v22, s[44:47], s55 offen offset:0 sc1 lds
    v_mfma_f32_32x32x16_bf16 v[72:87], v[152:155], v[124:127], 0
    ds_read_b64_tr_b16 v[152:153], v19 offset:2560
    ds_read_b64_tr_b16 v[154:155], v19 offset:2720
    s_waitcnt lgkmcnt(4)
    v_mfma_f32_32x32x16_bf16 v[40:55], v[156:159], v[120:123], 0
    buffer_load_dwordx4 v22, s[44:47], s55 offen offset:1024 sc1 lds
    v_mfma_f32_32x32x16_bf16 v[88:103], v[156:159], v[124:127], 0
    ds_read_b64_tr_b16 v[156:157], v20 offset:2560
    ds_read_b64_tr_b16 v[158:159], v20 offset:2720
    s_waitcnt lgkmcnt(4)
    v_mfma_f32_32x32x16_bf16 v[56:71], v[160:163], v[120:123], 0
    buffer_load_dwordx4 v22, s[44:47], s55 offen offset:2048 sc1 lds
    v_mfma_f32_32x32x16_bf16 v[104:119], v[160:163], v[124:127], 0
    ds_read_b64_tr_b16 v[160:161], v21 offset:2560
    ds_read_b64_tr_b16 v[162:163], v21 offset:2720
    s_lshl_b32 s56, s66, 11
    s_add_u32 s56, s56, s57
    s_add_u32 s52, s56, s14
    buffer_load_dwordx4 v[120:123], v22, s[44:47], s56 offen offset:0 sc1
    buffer_load_dwordx4 v[124:127], v22, s[44:47], s52 offen offset:0 sc1
    s_waitcnt vmcnt(9)
    s_waitcnt lgkmcnt(4)
    v_mfma_f32_32x32x16_bf16 v[24:39], v[152:155], v[128:131], v[24:39]
    buffer_load_dwordx4 v22, s[44:47], s55 offen offset:3072 sc1 lds
    v_mfma_f32_32x32x16_bf16 v[72:87], v[152:155], v[132:135], v[72:87]
    ds_read_b64_tr_b16 v[152:153], v19 offset:5120
    ds_read_b64_tr_b16 v[154:155], v19 offset:5280
    s_waitcnt lgkmcnt(4)
    v_mfma_f32_32x32x16_bf16 v[40:55], v[156:159], v[128:131], v[40:55]
    s_add_u32 m0, s54, 19456
    s_add_u32 s55, s55, 4096
    buffer_load_dwordx4 v22, s[44:47], s55 offen sc1 lds
    v_mfma_f32_32x32x16_bf16 v[88:103], v[156:159], v[132:135], v[88:103]
    ds_read_b64_tr_b16 v[156:157], v20 offset:5120
    ds_read_b64_tr_b16 v[158:159], v20 offset:5280
    s_waitcnt lgkmcnt(4)
    v_mfma_f32_32x32x16_bf16 v[56:71], v[160:163], v[128:131], v[56:71]
    s_mul_i32 s55, s68, 5120
    s_add_u32 s55, s55, s59
    s_add_u32 m0, s54, 20480
    s_nop 0
    buffer_load_dwordx4 v22, s[44:47], s55 offen offset:0 sc1 lds
    v_mfma_f32_32x32x16_bf16 v[104:119], v[160:163], v[132:135], v[104:119]
    ds_read_b64_tr_b16 v[160:161], v21 offset:5120
    ds_read_b64_tr_b16 v[162:163], v21 offset:5280
    s_lshl_b32 s56, s66, 11
    s_add_u32 s56, s56, s57
    s_add_u32 s52, s56, s14
    buffer_load_dwordx4 v[128:131], v22, s[44:47], s56 offen offset:1024 sc1
    buffer_load_dwordx4 v[132:135], v22, s[44:47], s52 offen offset:1024 sc1
    s_waitcnt vmcnt(12)
    s_waitcnt lgkmcnt(4)
    v_mfma_f32_32x32x16_bf16 v[24:39], v[152:155], v[136:139], v[24:39]
    buffer_load_dwordx4 v22, s[44:47], s55 offen offset:1024 sc1 lds
    v_mfma_f32_32x32x16_bf16 v[72:87], v[152:155], v[140:143], v[72:87]
    ds_read_b64_tr_b16 v[152:153], v19 offset:7680
    ds_read_b64_tr_b16 v[154:155], v19 offset:7840
    s_waitcnt lgkmcnt(4)
    v_mfma_f32_32x32x16_bf16 v[40:55], v[156:159], v[136:139], v[40:55]
    buffer_load_dwordx4 v22, s[44:47], s55 offen offset:2048 sc1 lds
    v_mfma_f32_32x32x16_bf16 v[88:103], v[156:159], v[140:143], v[88:103]
    ds_read_b64_tr_b16 v[156:157], v20 offset:7680
    ds_read_b64_tr_b16 v[158:159], v20 offset:7840
    s_waitcnt lgkmcnt(4)
    v_mfma_f32_32x32x16_bf16 v[56:71], v[160:163], v[136:139], v[56:71]
    buffer_load_dwordx4 v22, s[44:47], s55 offen offset:3072 sc1 lds
    v_mfma_f32_32x32x16_bf16 v[104:119], v[160:163], v[140:143], v[104:119]
    ds_read_b64_tr_b16 v[160:161], v21 offset:7680
    ds_read_b64_tr_b16 v[162:163], v21 offset:7840
    s_lshl_b32 s56, s67, 11
    s_add_u32 s56, s56, s57
    s_add_u32 s52, s56, s14
    buffer_load_dwordx4 v[136:139], v22, s[44:47], s56 offen offset:0 sc1
    buffer_load_dwordx4 v[140:143], v22, s[44:47], s52 offen offset:0 sc1
    s_waitcnt vmcnt(15)
    s_waitcnt lgkmcnt(4)
    v_mfma_f32_32x32x16_bf16 v[24:39], v[152:155], v[144:147], v[24:39]
    s_add_u32 m0, s54, 24576
    s_add_u32 s55, s55, 4096
    buffer_load_dwordx4 v22, s[44:47], s55 offen sc1 lds
    v_mfma_f32_32x32x16_bf16 v[72:87], v[152:155], v[148:151], v[72:87]
    ds_read_b64_tr_b16 v[152:153], v19 offset:10240
    ds_read_b64_tr_b16 v[154:155], v19 offset:10400
    s_waitcnt lgkmcnt(4)
    v_mfma_f32_32x32x16_bf16 v[40:55], v[156:159], v[144:147], v[40:55]
    s_mul_i32 s55, s69, 5120
    s_add_u32 s55, s55, s59
    s_add_u32 m0, s54, 0
    s_nop 0
    buffer_load_dwordx4 v22, s[44:47], s55 offen offset:0 sc1 lds
    v_mfma_f32_32x32x16_bf16 v[88:103], v[156:159], v[148:151], v[88:103]
    ds_read_b64_tr_b16 v[156:157], v20 offset:10240
    ds_read_b64_tr_b16 v[158:159], v20 offset:10400
    s_waitcnt lgkmcnt(4)
    v_mfma_f32_32x32x16_bf16 v[56:71], v[160:163], v[144:147], v[56:71]
    buffer_load_dwordx4 v22, s[44:47], s55 offen offset:1024 sc1 lds
    v_mfma_f32_32x32x16_bf16 v[104:119], v[160:163], v[148:151], v[104:119]
    ds_read_b64_tr_b16 v[160:161], v21 offset:10240
    ds_read_b64_tr_b16 v[162:163], v21 offset:10400
    s_lshl_b32 s56, s67, 11
    s_add_u32 s56, s56, s57
    s_add_u32 s52, s56, s14
    buffer_load_dwordx4 v[144:147], v22, s[44:47], s56 offen offset:1024 sc1
    buffer_load_dwordx4 v[148:151], v22, s[44:47], s52 offen offset:1024 sc1
    s_waitcnt vmcnt(15)
    s_waitcnt lgkmcnt(4)
    v_mfma_f32_32x32x16_bf16 v[24:39], v[152:155], v[120:123], v[24:39]
    buffer_load_dwordx4 v22, s[44:47], s55 offen offset:2048 sc1 lds
    v_mfma_f32_32x32x16_bf16 v[72:87], v[152:155], v[124:127], v[72:87]
    ds_read_b64_tr_b16 v[152:153], v19 offset:12800
    ds_read_b64_tr_b16 v[154:155], v19 offset:12960
    s_waitcnt lgkmcnt(4)
    v_mfma_f32_32x32x16_bf16 v[40:55], v[156:159], v[120:123], v[40:55]
    buffer_load_dwordx4 v22, s[44:47], s55 offen offset:3072 sc1 lds
    v_mfma_f32_32x32x16_bf16 v[88:103], v[156:159], v[124:127], v[88:103]
    ds_read_b64_tr_b16 v[156:157], v20 offset:12800
    ds_read_b64_tr_b16 v[158:159], v20 offset:12960
    s_waitcnt lgkmcnt(4)
    v_mfma_f32_32x32x16_bf16 v[56:71], v[160:163], v[120:123], v[56:71]
    s_add_u32 m0, s54, 4096
    s_add_u32 s55, s55, 4096
    buffer_load_dwordx4 v22, s[44:47], s55 offen sc1 lds
    v_mfma_f32_32x32x16_bf16 v[104:119], v[160:163], v[124:127], v[104:119]
    ds_read_b64_tr_b16 v[160:161], v21 offset:12800
    ds_read_b64_tr_b16 v[162:163], v21 offset:12960
    s_lshl_b32 s56, s68, 11
    s_add_u32 s56, s56, s57
    s_add_u32 s52, s56, s14
    buffer_load_dwordx4 v[120:123], v22, s[44:47], s56 offen offset:0 sc1
    buffer_load_dwordx4 v[124:127], v22, s[44:47], s52 offen offset:0 sc1
    s_waitcnt vmcnt(15)
    s_waitcnt lgkmcnt(4)
    v_mfma_f32_32x32x16_bf16 v[24:39], v[152:155], v[128:131], v[24:39]
    s_mul_i32 s55, s70, 5120
    s_add_u32 s55, s55, s59
    s_add_u32 m0, s54, 5120
    s_nop 0
    buffer_load_dwordx4 v22, s[44:47], s55 offen offset:0 sc1 lds
    v_mfma_f32_32x32x16_bf16 v[72:87], v[152:155], v[132:135], v[72:87]
    ds_read_b64_tr_b16 v[152:153], v19 offset:15360
    ds_read_b64_tr_b16 v[154:155], v19 offset:15520
    s_waitcnt lgkmcnt(4)
    v_mfma_f32_32x32x16_bf16 v[40:55], v[156:159], v[128:131], v[40:55]
    buffer_load_dwordx4 v22, s[44:47], s55 offen offset:1024 sc1 lds
    v_mfma_f32_32x32x16_bf16 v[88:103], v[156:159], v[132:135], v[88:103]
    ds_read_b64_tr_b16 v[156:157], v20 offset:15360
    ds_read_b64_tr_b16 v[158:159], v20 offset:15520
    s_waitcnt lgkmcnt(4)
    v_mfma_f32_32x32x16_bf16 v[56:71], v[160:163], v[128:131], v[56:71]
    buffer_load_dwordx4 v22, s[44:47], s55 offen offset:2048 sc1 lds
    v_mfma_f32_32x32x16_bf16 v[104:119], v[160:163], v[132:135], v[104:119]
    ds_read_b64_tr_b16 v[160:161], v21 offset:15360
    ds_read_b64_tr_b16 v[162:163], v21 offset:15520
    s_lshl_b32 s56, s68, 11
    s_add_u32 s56, s56, s57
    s_add_u32 s52, s56, s14
    buffer_load_dwordx4 v[128:131], v22, s[44:47], s56 offen offset:1024 sc1
    buffer_load_dwordx4 v[132:135], v22, s[44:47], s52 offen offset:1024 sc1
    s_waitcnt vmcnt(15)
    s_waitcnt lgkmcnt(4)
    v_mfma_f32_32x32x16_bf16 v[24:39], v[152:155], v[136:139], v[24:39]
    buffer_load_dwordx4 v22, s[44:47], s55 offen offset:3072 sc1 lds
    v_mfma_f32_32x32x16_bf16 v[72:87], v[152:155], v[140:143], v[72:87]
    ds_read_b64_tr_b16 v[152:153], v19 offset:17920
    ds_read_b64_tr_b16 v[154:155], v19 offset:18080
    s_waitcnt lgkmcnt(4)
    v_mfma_f32_32x32x16_bf16 v[40:55], v[156:159], v[136:139], v[40:55]
    s_add_u32 m0, s54, 9216
    s_add_u32 s55, s55, 4096
    buffer_load_dwordx4 v22, s[44:47], s55 offen sc1 lds
    v_mfma_f32_32x32x16_bf16 v[88:103], v[156:159], v[140:143], v[88:103]
    ds_read_b64_tr_b16 v[156:157], v20 offset:17920
    ds_read_b64_tr_b16 v[158:159], v20 offset:18080
    s_waitcnt lgkmcnt(4)
    v_mfma_f32_32x32x16_bf16 v[56:71], v[160:163], v[136:139], v[56:71]
    s_mul_i32 s55, s71, 5120
    s_add_u32 s55, s55, s59
    s_add_u32 m0, s54, 10240
    s_nop 0
    buffer_load_dwordx4 v22, s[44:47], s55 offen offset:0 sc1 lds
    v_mfma_f32_32x32x16_bf16 v[104:119], v[160:163], v[140:143], v[104:119]
    ds_read_b64_tr_b16 v[160:161], v21 offset:17920
    ds_read_b64_tr_b16 v[162:163], v21 offset:18080
    s_lshl_b32 s56, s69, 11
    s_add_u32 s56, s56, s57
    s_add_u32 s52, s56, s14
    buffer_load_dwordx4 v[136:139], v22, s[44:47], s56 offen offset:0 sc1
    buffer_load_dwordx4 v[140:143], v22, s[44:47], s52 offen offset:0 sc1
    s_waitcnt vmcnt(15)
    s_waitcnt lgkmcnt(4)
    v_mfma_f32_32x32x16_bf16 v[24:39], v[152:155], v[144:147], v[24:39]
    buffer_load_dwordx4 v22, s[44:47], s55 offen offset:1024 sc1 lds
    v_mfma_f32_32x32x16_bf16 v[72:87], v[152:155], v[148:151], v[72:87]
    ds_read_b64_tr_b16 v[152:153], v19 offset:20480
    ds_read_b64_tr_b16 v[154:155], v19 offset:20640
    s_waitcnt lgkmcnt(4)
    v_mfma_f32_32x32x16_bf16 v[40:55], v[156:159], v[144:147], v[40:55]
    buffer_load_dwordx4 v22, s[44:47], s55 offen offset:2048 sc1 lds
    v_mfma_f32_32x32x16_bf16 v[88:103], v[156:159], v[148:151], v[88:103]
    ds_read_b64_tr_b16 v[156:157], v20 offset:20480
    ds_read_b64_tr_b16 v[158:159], v20 offset:20640
    s_waitcnt lgkmcnt(4)
    v_mfma_f32_32x32x16_bf16 v[56:71], v[160:163], v[144:147], v[56:71]
    buffer_load_dwordx4 v22, s[44:47], s55 offen offset:3072 sc1 lds
    v_mfma_f32_32x32x16_bf16 v[104:119], v[160:163], v[148:151], v[104:119]
    ds_read_b64_tr_b16 v[160:161], v21 offset:20480
    ds_read_b64_tr_b16 v[162:163], v21 offset:20640
    s_lshl_b32 s56, s69, 11
    s_add_u32 s56, s56, s57
    s_add_u32 s52, s56, s14
    buffer_load_dwordx4 v[144:147], v22, s[44:47], s56 offen offset:1024 sc1
    buffer_load_dwordx4 v[148:151], v22, s[44:47], s52 offen offset:1024 sc1
    s_waitcnt vmcnt(15)
    s_waitcnt lgkmcnt(4)
    v_mfma_f32_32x32x16_bf16 v[24:39], v[152:155], v[120:123], v[24:39]
    s_add_u32 m0, s54, 14336
    s_add_u32 s55, s55, 4096
    buffer_load_dwordx4 v22, s[44:47], s55 offen sc1 lds
    v_mfma_f32_32x32x16_bf16 v[72:87], v[152:155], v[124:127], v[72:87]
    ds_read_b64_tr_b16 v[152:153], v19 offset:23040
    ds_read_b64_tr_b16 v[154:155], v19 offset:23200
    s_waitcnt lgkmcnt(4)
    v_mfma_f32_32x32x16_bf16 v[40:55], v[156:159], v[120:123], v[40:55]
    s_mul_i32 s55, s72, 5120
    s_add_u32 s55, s55, s59
    s_add_u32 m0, s54, 15360
    s_nop 0
    buffer_load_dwordx4 v22, s[44:47], s55 offen offset:0 sc1 lds
    v_mfma_f32_32x32x16_bf16 v[88:103], v[156:159], v[124:127], v[88:103]
    ds_read_b64_tr_b16 v[156:157], v20 offset:23040
    ds_read_b64_tr_b16 v[158:159], v20 offset:23200
    s_waitcnt lgkmcnt(4)
    v_mfma_f32_32x32x16_bf16 v[56:71], v[160:163], v[120:123], v[56:71]
    buffer_load_dwordx4 v22, s[44:47], s55 offen offset:1024 sc1 lds
    v_mfma_f32_32x32x16_bf16 v[104:119], v[160:163], v[124:127], v[104:119]
    ds_read_b64_tr_b16 v[160:161], v21 offset:23040
    ds_read_b64_tr_b16 v[162:163], v21 offset:23200
    buffer_load_dwordx2 v[164:165], v23, s[44:47], s58 offen sc1
    s_lshl_b32 s56, s70, 11
    s_add_u32 s56, s56, s57
    s_add_u32 s52, s56, s14
    buffer_load_dwordx4 v[120:123], v22, s[44:47], s56 offen offset:0 sc1
    buffer_load_dwordx4 v[124:127], v22, s[44:47], s52 offen offset:0 sc1
    s_waitcnt vmcnt(16)
    s_waitcnt lgkmcnt(4)
    v_mfma_f32_32x32x16_bf16 v[24:39], v[152:155], v[128:131], v[24:39]
    buffer_load_dwordx4 v22, s[44:47], s55 offen offset:2048 sc1 lds
    v_mfma_f32_32x32x16_bf16 v[72:87], v[152:155], v[132:135], v[72:87]
    ds_read_b64_tr_b16 v[152:153], v19 offset:0
    ds_read_b64_tr_b16 v[154:155], v19 offset:160
    s_waitcnt lgkmcnt(4)
    v_mfma_f32_32x32x16_bf16 v[40:55], v[156:159], v[128:131], v[40:55]
    buffer_load_dwordx4 v22, s[44:47], s55 offen offset:3072 sc1 lds
    v_mfma_f32_32x32x16_bf16 v[88:103], v[156:159], v[132:135], v[88:103]
    ds_read_b64_tr_b16 v[156:157], v20 offset:0
    ds_read_b64_tr_b16 v[158:159], v20 offset:160
    s_waitcnt lgkmcnt(4)
    v_mfma_f32_32x32x16_bf16 v[56:71], v[160:163], v[128:131], v[56:71]
    s_add_u32 m0, s54, 19456
    s_add_u32 s55, s55, 4096
    buffer_load_dwordx4 v22, s[44:47], s55 offen sc1 lds
    v_mfma_f32_32x32x16_bf16 v[104:119], v[160:163], v[132:135], v[104:119]
    ds_read_b64_tr_b16 v[160:161], v21 offset:0
    ds_read_b64_tr_b16 v[162:163], v21 offset:160
    s_lshl_b32 s56, s70, 11
    s_add_u32 s56, s56, s57
    s_add_u32 s52, s56, s14
    buffer_load_dwordx4 v[128:131], v22, s[44:47], s56 offen offset:1024 sc1
    buffer_load_dwordx4 v[132:135], v22, s[44:47], s52 offen offset:1024 sc1
    s_waitcnt vmcnt(16)
    s_waitcnt lgkmcnt(4)
    v_mfma_f32_32x32x16_bf16 v[24:39], v[152:155], v[136:139], v[24:39]
    s_mul_i32 s55, s73, 5120
    s_add_u32 s55, s55, s59
    s_add_u32 m0, s54, 20480
    s_nop 0
    buffer_load_dwordx4 v22, s[44:47], s55 offen offset:0 sc1 lds
    v_mfma_f32_32x32x16_bf16 v[72:87], v[152:155], v[140:143], v[72:87]
    ds_read_b64_tr_b16 v[152:153], v19 offset:2560
    ds_read_b64_tr_b16 v[154:155], v19 offset:2720
    s_waitcnt lgkmcnt(4)
    v_mfma_f32_32x32x16_bf16 v[40:55], v[156:159], v[136:139], v[40:55]
    buffer_load_dwordx4 v22, s[44:47], s55 offen offset:1024 sc1 lds
    v_mfma_f32_32x32x16_bf16 v[88:103], v[156:159], v[140:143], v[88:103]
    ds_read_b64_tr_b16 v[156:157], v20 offset:2560
    ds_read_b64_tr_b16 v[158:159], v20 offset:2720
    s_waitcnt lgkmcnt(4)
    v_mfma_f32_32x32x16_bf16 v[56:71], v[160:163], v[136:139], v[56:71]
    buffer_load_dwordx4 v22, s[44:47], s55 offen offset:2048 sc1 lds
    v_mfma_f32_32x32x16_bf16 v[104:119], v[160:163], v[140:143], v[104:119]
    ds_read_b64_tr_b16 v[160:161], v21 offset:2560
    ds_read_b64_tr_b16 v[162:163], v21 offset:2720
    s_lshl_b32 s56, s71, 11
    s_add_u32 s56, s56, s57
    s_add_u32 s52, s56, s14
    buffer_load_dwordx4 v[136:139], v22, s[44:47], s56 offen offset:0 sc1
    buffer_load_dwordx4 v[140:143], v22, s[44:47], s52 offen offset:0 sc1
    s_waitcnt vmcnt(16)
    s_waitcnt lgkmcnt(4)
    v_mfma_f32_32x32x16_bf16 v[24:39], v[152:155], v[144:147], v[24:39]
    buffer_load_dwordx4 v22, s[44:47], s55 offen offset:3072 sc1 lds
    v_mfma_f32_32x32x16_bf16 v[72:87], v[152:155], v[148:151], v[72:87]
    ds_read_b64_tr_b16 v[152:153], v19 offset:5120
    ds_read_b64_tr_b16 v[154:155], v19 offset:5280
    s_waitcnt lgkmcnt(4)
    v_mfma_f32_32x32x16_bf16 v[40:55], v[156:159], v[144:147], v[40:55]
    s_add_u32 m0, s54, 24576
    s_add_u32 s55, s55, 4096
    buffer_load_dwordx4 v22, s[44:47], s55 offen sc1 lds
    v_mfma_f32_32x32x16_bf16 v[88:103], v[156:159], v[148:151], v[88:103]
    ds_read_b64_tr_b16 v[156:157], v20 offset:5120
    ds_read_b64_tr_b16 v[158:159], v20 offset:5280
    s_waitcnt lgkmcnt(4)
    v_mfma_f32_32x32x16_bf16 v[56:71], v[160:163], v[144:147], v[56:71]
    v_mfma_f32_32x32x16_bf16 v[104:119], v[160:163], v[148:151], v[104:119]
    ds_read_b64_tr_b16 v[160:161], v21 offset:5120
    ds_read_b64_tr_b16 v[162:163], v21 offset:5280
    s_lshl_b32 s56, s71, 11
    s_add_u32 s56, s56, s57
    s_add_u32 s52, s56, s14
    buffer_load_dwordx4 v[144:147], v22, s[44:47], s56 offen offset:1024 sc1
    buffer_load_dwordx4 v[148:151], v22, s[44:47], s52 offen offset:1024 sc1
    s_waitcnt vmcnt(14)
    s_waitcnt lgkmcnt(4)
    v_mfma_f32_32x32x16_bf16 v[24:39], v[152:155], v[120:123], v[24:39]
    s_mul_i32 s55, s74, 5120
    s_add_u32 s55, s55, s59
    s_add_u32 m0, s54, 0
    s_nop 0
    buffer_load_dwordx4 v22, s[44:47], s55 offen offset:0 sc1 lds
    v_mfma_f32_32x32x16_bf16 v[72:87], v[152:155], v[124:127], v[72:87]
    ds_read_b64_tr_b16 v[152:153], v19 offset:7680
    ds_read_b64_tr_b16 v[154:155], v19 offset:7840
    s_waitcnt lgkmcnt(4)
    v_mfma_f32_32x32x16_bf16 v[40:55], v[156:159], v[120:123], v[40:55]
    buffer_load_dwordx4 v22, s[44:47], s55 offen offset:1024 sc1 lds
    v_mfma_f32_32x32x16_bf16 v[88:103], v[156:159], v[124:127], v[88:103]
    ds_read_b64_tr_b16 v[156:157], v20 offset:7680
    ds_read_b64_tr_b16 v[158:159], v20 offset:7840
    s_waitcnt lgkmcnt(4)
    v_mfma_f32_32x32x16_bf16 v[56:71], v[160:163], v[120:123], v[56:71]
    buffer_load_dwordx4 v22, s[44:47], s55 offen offset:2048 sc1 lds
    v_mfma_f32_32x32x16_bf16 v[104:119], v[160:163], v[124:127], v[104:119]
    ds_read_b64_tr_b16 v[160:161], v21 offset:7680
    ds_read_b64_tr_b16 v[162:163], v21 offset:7840
    s_waitcnt vmcnt(19)
    s_setprio 3
    v_cmp_ne_u64 vcc, s[30:31], v[164:165]
    s_nop 1
    s_cmp_eq_u64 vcc, 0
    s_cbranch_scc1 G_F2OK
    s_mov_b32 s63, 200000
POLL_97:
    buffer_load_dwordx2 v[164:165], v23, s[44:47], s58 offen sc1
    s_waitcnt vmcnt(0)
    v_cmp_ne_u64 vcc, s[30:31], v[164:165]
    s_nop 1
    s_cmp_eq_u64 vcc, 0
    s_cbranch_scc1 POLLD_98
    s_sleep 8
    s_sub_u32 s63, s63, 1
    s_cmp_lg_u32 s63, 0
    s_cbranch_scc1 POLL_97
POLLD_98:
G_F2OK:
    s_setprio 0
    s_lshl_b32 s56, s72, 11
    s_add_u32 s56, s56, s57
    s_add_u32 s52, s56, s14
    buffer_load_dwordx4 v[120:123], v22, s[44:47], s56 offen offset:0 sc1
    buffer_load_dwordx4 v[124:127], v22, s[44:47], s52 offen offset:0 sc1
    s_waitcnt vmcnt(14)
    s_waitcnt lgkmcnt(4)
    v_mfma_f32_32x32x16_bf16 v[24:39], v[152:155], v[128:131], v[24:39]
    buffer_load_dwordx4 v22, s[44:47], s55 offen offset:3072 sc1 lds
    v_mfma_f32_32x32x16_bf16 v[72:87], v[152:155], v[132:135], v[72:87]
    ds_read_b64_tr_b16 v[152:153], v19 offset:10240
    ds_read_b64_tr_b16 v[154:155], v19 offset:10400
    s_waitcnt lgkmcnt(4)
    v_mfma_f32_32x32x16_bf16 v[40:55], v[156:159], v[128:131], v[40:55]
    s_add_u32 m0, s54, 4096
    s_add_u32 s55, s55, 4096
    buffer_load_dwordx4 v22, s[44:47], s55 offen sc1 lds
    v_mfma_f32_32x32x16_bf16 v[88:103], v[156:159], v[132:135], v[88:103]
    ds_read_b64_tr_b16 v[156:157], v20 offset:10240
    ds_read_b64_tr_b16 v[158:159], v20 offset:10400
    s_waitcnt lgkmcnt(4)
    v_mfma_f32_32x32x16_bf16 v[56:71], v[160:163], v[128:131], v[56:71]
    v_mfma_f32_32x32x16_bf16 v[104:119], v[160:163], v[132:135], v[104:119]
    ds_read_b64_tr_b16 v[160:161], v21 offset:10240
    ds_read_b64_tr_b16 v[162:163], v21 offset:10400
    s_lshl_b32 s56, s72, 11
    s_add_u32 s56, s56, s57
    s_add_u32 s52, s56, s14
    buffer_load_dwordx4 v[128:131], v22, s[44:47], s56 offen offset:1024 sc1
    buffer_load_dwordx4 v[132:135], v22, s[44:47], s52 offen offset:1024 sc1
    s_waitcnt vmcnt(13)
    s_waitcnt lgkmcnt(4)
    v_mfma_f32_32x32x16_bf16 v[24:39], v[152:155], v[136:139], v[24:39]
    s_mul_i32 s55, s75, 5120
    s_add_u32 s55, s55, s59
    s_add_u32 m0, s54, 5120
    s_nop 0
    buffer_load_dwordx4 v22, s[44:47], s55 offen offset:0 sc1 lds
    v_mfma_f32_32x32x16_bf16 v[72:87], v[152:155], v[140:143], v[72:87]
    ds_read_b64_tr_b16 v[152:153], v19 offset:12800
    ds_read_b64_tr_b16 v[154:155], v19 offset:12960
    s_waitcnt lgkmcnt(4)
    v_mfma_f32_32x32x16_bf16 v[40:55], v[156:159], v[136:139], v[40:55]
    buffer_load_dwordx4 v22, s[44:47], s55 offen offset:1024 sc1 lds
    v_mfma_f32_32x32x16_bf16 v[88:103], v[156:159], v[140:143], v[88:103]
    ds_read_b64_tr_b16 v[156:157], v20 offset:12800
    ds_read_b64_tr_b16 v[158:159], v20 offset:12960
    s_waitcnt lgkmcnt(4)
    v_mfma_f32_32x32x16_bf16 v[56:71], v[160:163], v[136:139], v[56:71]
    buffer_load_dwordx4 v22, s[44:47], s55 offen offset:2048 sc1 lds
    v_mfma_f32_32x32x16_bf16 v[104:119], v[160:163], v[140:143], v[104:119]
    ds_read_b64_tr_b16 v[160:161], v21 offset:12800
    ds_read_b64_tr_b16 v[162:163], v21 offset:12960
    s_lshl_b32 s56, s73, 11
    s_add_u32 s56, s56, s57
    s_add_u32 s52, s56, s14
    buffer_load_dwordx4 v[136:139], v22, s[44:47], s56 offen offset:0 sc1
    buffer_load_dwordx4 v[140:143], v22, s[44:47], s52 offen offset:0 sc1
    s_waitcnt vmcnt(14)
    s_waitcnt lgkmcnt(4)
    v_mfma_f32_32x32x16_bf16 v[24:39], v[152:155], v[144:147], v[24:39]
    buffer_load_dwordx4 v22, s[44:47], s55 offen offset:3072 sc1 lds
    v_mfma_f32_32x32x16_bf16 v[72:87], v[152:155], v[148:151], v[72:87]
    ds_read_b64_tr_b16 v[152:153], v19 offset:15360
    ds_read_b64_tr_b16 v[154:155], v19 offset:15520
    s_waitcnt lgkmcnt(4)
    v_mfma_f32_32x32x16_bf16 v[40:55], v[156:159], v[144:147], v[40:55]
    s_add_u32 m0, s54, 9216
    s_add_u32 s55, s55, 4096
    buffer_load_dwordx4 v22, s[44:47], s55 offen sc1 lds
    v_mfma_f32_32x32x16_bf16 v[88:103], v[156:159], v[148:151], v[88:103]
    ds_read_b64_tr_b16 v[156:157], v20 offset:15360
    ds_read_b64_tr_b16 v[158:159], v20 offset:15520
    s_waitcnt lgkmcnt(4)
    v_mfma_f32_32x32x16_bf16 v[56:71], v[160:163], v[144:147], v[56:71]
    v_mfma_f32_32x32x16_bf16 v[104:119], v[160:163], v[148:151], v[104:119]
    ds_read_b64_tr_b16 v[160:161], v21 offset:15360
    ds_read_b64_tr_b16 v[162:163], v21 offset:15520
    s_lshl_b32 s56, s73, 11
    s_add_u32 s56, s56, s57
    s_add_u32 s52, s56, s14
    buffer_load_dwordx4 v[144:147], v22, s[44:47], s56 offen offset:1024 sc1
    buffer_load_dwordx4 v[148:151], v22, s[44:47], s52 offen offset:1024 sc1
    s_waitcnt vmcnt(13)
    s_waitcnt lgkmcnt(4)
    v_mfma_f32_32x32x16_bf16 v[24:39], v[152:155], v[120:123], v[24:39]
    s_mul_i32 s55, s76, 5120
    s_add_u32 s55, s55, s59
    s_add_u32 m0, s54, 10240
    s_nop 0
    buffer_load_dwordx4 v22, s[44:47], s55 offen offset:0 sc1 lds
    v_mfma_f32_32x32x16_bf16 v[72:87], v[152:155], v[124:127], v[72:87]
    ds_read_b64_tr_b16 v[152:153], v19 offset:17920
    ds_read_b64_tr_b16 v[154:155], v19 offset:18080
    s_waitcnt lgkmcnt(4)
    v_mfma_f32_32x32x16_bf16 v[40:55], v[156:159], v[120:123], v[40:55]
    buffer_load_dwordx4 v22, s[44:47], s55 offen offset:1024 sc1 lds
    v_mfma_f32_32x32x16_bf16 v[88:103], v[156:159], v[124:127], v[88:103]
    ds_read_b64_tr_b16 v[156:157], v20 offset:17920
    ds_read_b64_tr_b16 v[158:159], v20 offset:18080
    s_waitcnt lgkmcnt(4)
    v_mfma_f32_32x32x16_bf16 v[56:71], v[160:163], v[120:123], v[56:71]
    buffer_load_dwordx4 v22, s[44:47], s55 offen offset:2048 sc1 lds
    v_mfma_f32_32x32x16_bf16 v[104:119], v[160:163], v[124:127], v[104:119]
    ds_read_b64_tr_b16 v[160:161], v21 offset:17920
    ds_read_b64_tr_b16 v[162:163], v21 offset:18080
    s_lshl_b32 s56, s74, 11
    s_add_u32 s56, s56, s57
    s_add_u32 s52, s56, s14
    buffer_load_dwordx4 v[120:123], v22, s[44:47], s56 offen offset:0 sc1
    buffer_load_dwordx4 v[124:127], v22, s[44:47], s52 offen offset:0 sc1
    s_waitcnt vmcnt(14)
    s_waitcnt lgkmcnt(4)
    v_mfma_f32_32x32x16_bf16 v[24:39], v[152:155], v[128:131], v[24:39]
    buffer_load_dwordx4 v22, s[44:47], s55 offen offset:3072 sc1 lds
    v_mfma_f32_32x32x16_bf16 v[72:87], v[152:155], v[132:135], v[72:87]
    ds_read_b64_tr_b16 v[152:153], v19 offset:20480
    ds_read_b64_tr_b16 v[154:155], v19 offset:20640
    s_waitcnt lgkmcnt(4)
    v_mfma_f32_32x32x16_bf16 v[40:55], v[156:159], v[128:131], v[40:55]
    s_add_u32 m0, s54, 14336
    s_add_u32 s55, s55, 4096
    buffer_load_dwordx4 v22, s[44:47], s55 offen sc1 lds
    v_mfma_f32_32x32x16_bf16 v[88:103], v[156:159], v[132:135], v[88:103]
    ds_read_b64_tr_b16 v[156:157], v20 offset:20480
    ds_read_b64_tr_b16 v[158:159], v20 offset:20640
    s_waitcnt lgkmcnt(4)
    v_mfma_f32_32x32x16_bf16 v[56:71], v[160:163], v[128:131], v[56:71]
    v_mfma_f32_32x32x16_bf16 v[104:119], v[160:163], v[132:135], v[104:119]
    ds_read_b64_tr_b16 v[160:161], v21 offset:20480
    ds_read_b64_tr_b16 v[162:163], v21 offset:20640
    s_lshl_b32 s56, s74, 11
    s_add_u32 s56, s56, s57
    s_add_u32 s52, s56, s14
    buffer_load_dwordx4 v[128:131], v22, s[44:47], s56 offen offset:1024 sc1
    buffer_load_dwordx4 v[132:135], v22, s[44:47], s52 offen offset:1024 sc1
    s_waitcnt vmcnt(13)
    s_waitcnt lgkmcnt(4)
    v_mfma_f32_32x32x16_bf16 v[24:39], v[152:155], v[136:139], v[24:39]
    s_mul_i32 s55, s77, 5120
    s_add_u32 s55, s55, s59
    s_add_u32 m0, s54, 15360
    s_nop 0
    buffer_load_dwordx4 v22, s[44:47], s55 offen offset:0 sc1 lds
    v_mfma_f32_32x32x16_bf16 v[72:87], v[152:155], v[140:143], v[72:87]
    ds_read_b64_tr_b16 v[152:153], v19 offset:23040
    ds_read_b64_tr_b16 v[154:155], v19 offset:23200
    s_waitcnt lgkmcnt(4)
    v_mfma_f32_32x32x16_bf16 v[40:55], v[156:159], v[136:139], v[40:55]
    buffer_load_dwordx4 v22, s[44:47], s55 offen offset:1024 sc1 lds
    v_mfma_f32_32x32x16_bf16 v[88:103], v[156:159], v[140:143], v[88:103]
    ds_read_b64_tr_b16 v[156:157], v20 offset:23040
    ds_read_b64_tr_b16 v[158:159], v20 offset:23200
    s_waitcnt lgkmcnt(4)
    v_mfma_f32_32x32x16_bf16 v[56:71], v[160:163], v[136:139], v[56:71]
    buffer_load_dwordx4 v22, s[44:47], s55 offen offset:2048 sc1 lds
    v_mfma_f32_32x32x16_bf16 v[104:119], v[160:163], v[140:143], v[104:119]
    ds_read_b64_tr_b16 v[160:161], v21 offset:23040
    ds_read_b64_tr_b16 v[162:163], v21 offset:23200
    s_lshl_b32 s56, s75, 11
    s_add_u32 s56, s56, s57
    s_add_u32 s52, s56, s14
    buffer_load_dwordx4 v[136:139], v22, s[44:47], s56 offen offset:0 sc1
    buffer_load_dwordx4 v[140:143], v22, s[44:47], s52 offen offset:0 sc1
    s_waitcnt vmcnt(14)
    s_waitcnt lgkmcnt(4)
    v_mfma_f32_32x32x16_bf16 v[24:39], v[152:155], v[144:147], v[24:39]
    buffer_load_dwordx4 v22, s[44:47], s55 offen offset:3072 sc1 lds
    v_mfma_f32_32x32x16_bf16 v[72:87], v[152:155], v[148:151], v[72:87]
    ds_read_b64_tr_b16 v[152:153], v19 offset:0
    ds_read_b64_tr_b16 v[154:155], v19 offset:160
    s_waitcnt lgkmcnt(4)
    v_mfma_f32_32x32x16_bf16 v[40:55], v[156:159], v[144:147], v[40:55]
    s_add_u32 m0, s54, 19456
    s_add_u32 s55, s55, 4096
    buffer_load_dwordx4 v22, s[44:47], s55 offen sc1 lds
    v_mfma_f32_32x32x16_bf16 v[88:103], v[156:159], v[148:151], v[88:103]
    ds_read_b64_tr_b16 v[156:157], v20 offset:0
    ds_read_b64_tr_b16 v[158:159], v20 offset:160
    s_waitcnt lgkmcnt(4)
    v_mfma_f32_32x32x16_bf16 v[56:71], v[160:163], v[144:147], v[56:71]
    v_mfma_f32_32x32x16_bf16 v[104:119], v[160:163], v[148:151], v[104:119]
    ds_read_b64_tr_b16 v[160:161], v21 offset:0
    ds_read_b64_tr_b16 v[162:163], v21 offset:160
    s_lshl_b32 s56, s75, 11
    s_add_u32 s56, s56, s57
    s_add_u32 s52, s56, s14
    buffer_load_dwordx4 v[144:147], v22, s[44:47], s56 offen offset:1024 sc1
    buffer_load_dwordx4 v[148:151], v22, s[44:47], s52 offen offset:1024 sc1
    s_mul_i32 s55, s61, 25600
    s_add_u32 s55, s55, 296960
    s_add_u32 s55, s55, s59
    s_add_u32 m0, s54, 20480
    s_nop 0
    buffer_load_dwordx4 v22, s[44:47], s55 offen offset:0 sc1 lds
    buffer_load_dwordx4 v22, s[44:47], s55 offen offset:1024 sc1 lds
    buffer_load_dwordx4 v22, s[44:47], s55 offen offset:2048 sc1 lds
    buffer_load_dwordx4 v22, s[44:47], s55 offen offset:3072 sc1 lds
    s_add_u32 m0, s54, 24576
    s_add_u32 s55, s55, 4096
    buffer_load_dwordx4 v22, s[44:47], s55 offen sc1 lds
    s_setprio 3
    s_mov_b32 s63, 1600000
LW_99:
    ds_read_b32 v2, v12 offset:272
    s_waitcnt lgkmcnt(0)
    v_readfirstlane_b32 s52, v2
    s_nop 1
    s_cmp_ge_u32 s52, 2128
    s_cbranch_scc1 LWD_100
    s_sleep 8
    s_sub_u32 s63, s63, 1
    s_cmp_lg_u32 s63, 0
    s_cbranch_scc1 LW_99
LWD_100:
    s_setprio 0
    s_waitcnt vmcnt(18)
    s_waitcnt lgkmcnt(4)
    v_mfma_f32_32x32x16_bf16 v[24:39], v[152:155], v[120:123], v[24:39]
    v_mfma_f32_32x32x16_bf16 v[72:87], v[152:155], v[124:127], v[72:87]
    ds_read_b64_tr_b16 v[152:153], v19 offset:2560
    ds_read_b64_tr_b16 v[154:155], v19 offset:2720
    s_waitcnt lgkmcnt(4)
    v_mfma_f32_32x32x16_bf16 v[40:55], v[156:159], v[120:123], v[40:55]
    v_mfma_f32_32x32x16_bf16 v[88:103], v[156:159], v[124:127], v[88:103]
    ds_read_b64_tr_b16 v[156:157], v20 offset:2560
    ds_read_b64_tr_b16 v[158:159], v20 offset:2720
    s_waitcnt lgkmcnt(4)
    v_mfma_f32_32x32x16_bf16 v[56:71], v[160:163], v[120:123], v[56:71]
    v_mfma_f32_32x32x16_bf16 v[104:119], v[160:163], v[124:127], v[104:119]
    ds_read_b64_tr_b16 v[160:161], v21 offset:2560
    ds_read_b64_tr_b16 v[162:163], v21 offset:2720
    s_lshl_b32 s56, s76, 11
    s_add_u32 s56, s56, s57
    s_add_u32 s52, s56, s14
    buffer_load_dwordx4 v[120:123], v22, s[44:47], s56 offen offset:0 sc1
    buffer_load_dwordx4 v[124:127], v22, s[44:47], s52 offen offset:0 sc1
    s_waitcnt vmcnt(16)
    s_waitcnt lgkmcnt(4)
    v_mfma_f32_32x32x16_bf16 v[24:39], v[152:155], v[128:131], v[24:39]
    v_mfma_f32_32x32x16_bf16 v[72:87], v[152:155], v[132:135], v[72:87]
    ds_read_b64_tr_b16 v[152:153], v19 offset:5120
    ds_read_b64_tr_b16 v[154:155], v19 offset:5280
    s_waitcnt lgkmcnt(4)
    v_mfma_f32_32x32x16_bf16 v[40:55], v[156:159], v[128:131], v[40:55]
    v_mfma_f32_32x32x16_bf16 v[88:103], v[156:159], v[132:135], v[88:103]
    ds_read_b64_tr_b16 v[156:157], v20 offset:5120
    ds_read_b64_tr_b16 v[158:159], v20 offset:5280
    s_waitcnt lgkmcnt(4)
    v_mfma_f32_32x32x16_bf16 v[56:71], v[160:163], v[128:131], v[56:71]
    v_mfma_f32_32x32x16_bf16 v[104:119], v[160:163], v[132:135], v[104:119]
    ds_read_b64_tr_b16 v[160:161], v21 offset:5120
    ds_read_b64_tr_b16 v[162:163], v21 offset:5280
    s_lshl_b32 s56, s76, 11
    s_add_u32 s56, s56, s57
    s_add_u32 s52, s56, s14
    buffer_load_dwordx4 v[128:131], v22, s[44:47], s56 offen offset:1024 sc1
    buffer_load_dwordx4 v[132:135], v22, s[44:47], s52 offen offset:1024 sc1
    s_waitcnt vmcnt(13)
    s_waitcnt lgkmcnt(4)
    v_mfma_f32_32x32x16_bf16 v[24:39], v[152:155], v[136:139], v[24:39]
    s_mul_i32 s55, s61, 25600
    s_add_u32 s55, s55, 276480
    s_add_u32 s55, s55, s59
    s_add_u32 m0, s54, 0
    s_nop 0
    buffer_load_dwordx4 v22, s[44:47], s55 offen offset:0 sc1 lds
    v_mfma_f32_32x32x16_bf16 v[72:87], v[152:155], v[140:143], v[72:87]
    ds_read_b64_tr_b16 v[152:153], v19 offset:7680
    ds_read_b64_tr_b16 v[154:155], v19 offset:7840
    s_waitcnt lgkmcnt(4)
    v_mfma_f32_32x32x16_bf16 v[40:55], v[156:159], v[136:139], v[40:55]
    buffer_load_dwordx4 v22, s[44:47], s55 offen offset:1024 sc1 lds
    v_mfma_f32_32x32x16_bf16 v[88:103], v[156:159], v[140:143], v[88:103]
    ds_read_b64_tr_b16 v[156:157], v20 offset:7680
    ds_read_b64_tr_b16 v[158:159], v20 offset:7840
    s_waitcnt lgkmcnt(4)
    v_mfma_f32_32x32x16_bf16 v[56:71], v[160:163], v[136:139], v[56:71]
    buffer_load_dwordx4 v22, s[44:47], s55 offen offset:2048 sc1 lds
    v_mfma_f32_32x32x16_bf16 v[104:119], v[160:163], v[140:143], v[104:119]
    ds_read_b64_tr_b16 v[160:161], v21 offset:7680
    ds_read_b64_tr_b16 v[162:163], v21 offset:7840
    s_lshl_b32 s56, s77, 11
    s_add_u32 s56, s56, s57
    s_add_u32 s52, s56, s14
    buffer_load_dwordx4 v[136:139], v22, s[44:47], s56 offen offset:0 sc1
    buffer_load_dwordx4 v[140:143], v22, s[44:47], s52 offen offset:0 sc1
    s_waitcnt vmcnt(14)
    s_waitcnt lgkmcnt(4)
    v_mfma_f32_32x32x16_bf16 v[24:39], v[152:155], v[144:147], v[24:39]
    buffer_load_dwordx4 v22, s[44:47], s55 offen offset:3072 sc1 lds
    v_mfma_f32_32x32x16_bf16 v[72:87], v[152:155], v[148:151], v[72:87]
    ds_read_b64_tr_b16 v[152:153], v19 offset:10240
    ds_read_b64_tr_b16 v[154:155], v19 offset:10400
    s_waitcnt lgkmcnt(4)
    v_mfma_f32_32x32x16_bf16 v[40:55], v[156:159], v[144:147], v[40:55]
    s_add_u32 m0, s54, 4096
    s_add_u32 s55, s55, 4096
    buffer_load_dwordx4 v22, s[44:47], s55 offen sc1 lds
    v_mfma_f32_32x32x16_bf16 v[88:103], v[156:159], v[148:151], v[88:103]
    ds_read_b64_tr_b16 v[156:157], v20 offset:10240
    ds_read_b64_tr_b16 v[158:159], v20 offset:10400
    s_waitcnt lgkmcnt(4)
    v_mfma_f32_32x32x16_bf16 v[56:71], v[160:163], v[144:147], v[56:71]
    v_mfma_f32_32x32x16_bf16 v[104:119], v[160:163], v[148:151], v[104:119]
    ds_read_b64_tr_b16 v[160:161], v21 offset:10240
    ds_read_b64_tr_b16 v[162:163], v21 offset:10400
    s_lshl_b32 s56, s77, 11
    s_add_u32 s56, s56, s57
    s_add_u32 s52, s56, s14
    buffer_load_dwordx4 v[144:147], v22, s[44:47], s56 offen offset:1024 sc1
    buffer_load_dwordx4 v[148:151], v22, s[44:47], s52 offen offset:1024 sc1
    s_waitcnt vmcnt(11)
    s_waitcnt lgkmcnt(4)
    v_mfma_f32_32x32x16_bf16 v[24:39], v[152:155], v[120:123], v[24:39]
    s_mul_i32 s55, s61, 25600
    s_add_u32 s55, s55, 281600
    s_add_u32 s55, s55, s59
    s_add_u32 m0, s54, 5120
    s_nop 0
    buffer_load_dwordx4 v22, s[44:47], s55 offen offset:0 sc1 lds
    v_mfma_f32_32x32x16_bf16 v[72:87], v[152:155], v[124:127], v[72:87]
    ds_read_b64_tr_b16 v[152:153], v19 offset:12800
    ds_read_b64_tr_b16 v[154:155], v19 offset:12960
    s_waitcnt lgkmcnt(4)
    v_mfma_f32_32x32x16_bf16 v[40:55], v[156:159], v[120:123], v[40:55]
    buffer_load_dwordx4 v22, s[44:47], s55 offen offset:1024 sc1 lds
    v_mfma_f32_32x32x16_bf16 v[88:103], v[156:159], v[124:127], v[88:103]
    ds_read_b64_tr_b16 v[156:157], v20 offset:12800
    ds_read_b64_tr_b16 v[158:159], v20 offset:12960
    s_waitcnt lgkmcnt(4)
    v_mfma_f32_32x32x16_bf16 v[56:71], v[160:163], v[120:123], v[56:71]
    buffer_load_dwordx4 v22, s[44:47], s55 offen offset:2048 sc1 lds
    v_mfma_f32_32x32x16_bf16 v[104:119], v[160:163], v[124:127], v[104:119]
    ds_read_b64_tr_b16 v[160:161], v21 offset:12800
    ds_read_b64_tr_b16 v[162:163], v21 offset:12960
    s_waitcnt vmcnt(12)
    s_waitcnt lgkmcnt(4)
    v_mfma_f32_32x32x16_bf16 v[24:39], v[152:155], v[128:131], v[24:39]
    buffer_load_dwordx4 v22, s[44:47], s55 offen offset:3072 sc1 lds
    v_mfma_f32_32x32x16_bf16 v[72:87], v[152:155], v[132:135], v[72:87]
    ds_read_b64_tr_b16 v[152:153], v19 offset:15360
    ds_read_b64_tr_b16 v[154:155], v19 offset:15520
    s_waitcnt lgkmcnt(4)
    v_mfma_f32_32x32x16_bf16 v[40:55], v[156:159], v[128:131], v[40:55]
    s_add_u32 m0, s54, 9216
    s_add_u32 s55, s55, 4096
    buffer_load_dwordx4 v22, s[44:47], s55 offen sc1 lds
    v_mfma_f32_32x32x16_bf16 v[88:103], v[156:159], v[132:135], v[88:103]
    ds_read_b64_tr_b16 v[156:157], v20 offset:15360
    ds_read_b64_tr_b16 v[158:159], v20 offset:15520
    s_waitcnt lgkmcnt(4)
    v_mfma_f32_32x32x16_bf16 v[56:71], v[160:163], v[128:131], v[56:71]
    v_mfma_f32_32x32x16_bf16 v[104:119], v[160:163], v[132:135], v[104:119]
    ds_read_b64_tr_b16 v[160:161], v21 offset:15360
    ds_read_b64_tr_b16 v[162:163], v21 offset:15520
    s_waitcnt vmcnt(9)
    s_waitcnt lgkmcnt(4)
    v_mfma_f32_32x32x16_bf16 v[24:39], v[152:155], v[136:139], v[24:39]
    s_mul_i32 s55, s61, 25600
    s_add_u32 s55, s55, 286720
    s_add_u32 s55, s55, s59
    s_add_u32 m0, s54, 10240
    s_nop 0
    buffer_load_dwordx4 v22, s[44:47], s55 offen offset:0 sc1 lds
    v_mfma_f32_32x32x16_bf16 v[72:87], v[152:155], v[140:143], v[72:87]
    ds_read_b64_tr_b16 v[152:153], v19 offset:17920
    ds_read_b64_tr_b16 v[154:155], v19 offset:18080
    s_waitcnt lgkmcnt(4)
    v_mfma_f32_32x32x16_bf16 v[40:55], v[156:159], v[136:139], v[40:55]
    buffer_load_dwordx4 v22, s[44:47], s55 offen offset:1024 sc1 lds
    v_mfma_f32_32x32x16_bf16 v[88:103], v[156:159], v[140:143], v[88:103]
    ds_read_b64_tr_b16 v[156:157], v20 offset:17920
    ds_read_b64_tr_b16 v[158:159], v20 offset:18080
    s_waitcnt lgkmcnt(4)
    v_mfma_f32_32x32x16_bf16 v[56:71], v[160:163], v[136:139], v[56:71]
    buffer_load_dwordx4 v22, s[44:47], s55 offen offset:2048 sc1 lds
    v_mfma_f32_32x32x16_bf16 v[104:119], v[160:163], v[140:143], v[104:119]
    ds_read_b64_tr_b16 v[160:161], v21 offset:17920
    ds_read_b64_tr_b16 v[162:163], v21 offset:18080
    s_waitcnt vmcnt(8)
    s_waitcnt lgkmcnt(4)
    v_mfma_f32_32x32x16_bf16 v[24:39], v[152:155], v[144:147], v[24:39]
    buffer_load_dwordx4 v22, s[44:47], s55 offen offset:3072 sc1 lds
    v_mfma_f32_32x32x16_bf16 v[72:87], v[152:155], v[148:151], v[72:87]
    s_waitcnt lgkmcnt(2)
    v_mfma_f32_32x32x16_bf16 v[40:55], v[156:159], v[144:147], v[40:55]
    s_add_u32 m0, s54, 14336
    s_add_u32 s55, s55, 4096
    buffer_load_dwordx4 v22, s[44:47], s55 offen sc1 lds
    v_mfma_f32_32x32x16_bf16 v[88:103], v[156:159], v[148:151], v[88:103]
    s_waitcnt lgkmcnt(0)
    v_mfma_f32_32x32x16_bf16 v[56:71], v[160:163], v[144:147], v[56:71]
    v_mfma_f32_32x32x16_bf16 v[104:119], v[160:163], v[148:151], v[104:119]
    s_mul_i32 s55, s61, 25600
    s_add_u32 s55, s55, 291840
    s_add_u32 s55, s55, s59
    s_add_u32 m0, s54, 15360
    s_nop 0
    buffer_load_dwordx4 v22, s[44:47], s55 offen offset:0 sc1 lds
    buffer_load_dwordx4 v22, s[44:47], s55 offen offset:1024 sc1 lds
    buffer_load_dwordx4 v22, s[44:47], s55 offen offset:2048 sc1 lds
    buffer_load_dwordx4 v22, s[44:47], s55 offen offset:3072 sc1 lds
    s_add_u32 m0, s54, 19456
    s_add_u32 s55, s55, 4096
    buffer_load_dwordx4 v22, s[44:47], s55 offen sc1 lds
    s_setprio 3
    s_mov_b32 s32, s4
    s_mov_b32 s33, s5
    s_mov_b32 s34, 2621440
    s_mov_b32 s35, 0x20000
    s_mov_b32 s40, s22
    s_mov_b32 s41, s23
    s_mov_b32 s42, 1280
    s_mov_b32 s43, 0x20000
    s_and_b32 s52, s61, 1
    s_lshl_b32 s52, s52, 1
    v_add_u32 v5, s52, v7
    v_lshlrev_b32 v3, 5, v5
    v_lshlrev_b32 v5, 3, v5
    v_mul_u32_u24 v14, 1280, v6
    v_add_u32 v11, v14, v5
    v_add_u32 v14, v14, v3
    s_mul_i32 s62, s49, 160
    s_lshl_b32 s60, s48, 1
    s_lshr_b32 s52, s61, 1
    s_add_u32 s60, s60, s52
    s_mul_i32 s60, s60, 40960
    s_add_u32 s60, s60, s62
    buffer_load_dwordx4 v[120:123], v14, s[32:35], s60 offen offset:0
    buffer_load_dwordx4 v[132:135], v3, s[40:43], s62 offen offset:0
    buffer_load_dwordx4 v[124:127], v14, s[32:35], s60 offen offset:16
    buffer_load_dwordx4 v[136:139], v3, s[40:43], s62 offen offset:16
    buffer_load_dwordx2 v[128:129], v11, s[32:35], s60 offen offset:128
    buffer_load_dwordx2 v[140:141], v5, s[40:43], s62 offen offset:128
    s_lshr_b32 s52, s61, 1
    s_lshl_b32 s52, s52, 7
    s_add_u32 s52, s52, 162816
    v_lshlrev_b32 v2, 2, v6
    v_add_u32 v2, s52, v2
    ds_read_b32 v9, v2
    s_lshl_b32 s58, s48, 13
    s_lshl_b32 s52, s61, 11
    s_add_u32 s58, s58, s52
    s_add_u32 s58, s58, 21233664
    v_and_b32 v23, 15, v1
    v_lshlrev_b32 v23, 7, v23
    s_lshl_b32 s57, s48, 2
    s_add_u32 s57, s57, s61
    s_mul_i32 s57, s57, 20480
    s_add_u32 s57, s57, 16777216
    s_mov_b32 s36, s24
    s_mov_b32 s37, s25
    s_mov_b32 s38, 2621440
    s_mov_b32 s39, 0x20000
    s_mul_i32 s52, s61, 10240
    v_add_u32 v15, s52, v22
    s_xor_b32 s52, s61, 2
    s_mul_i32 s52, s52, 10240
    v_add_u32 v16, s52, v22
    s_xor_b32 s52, s61, 3
    s_mul_i32 s52, s52, 10240
    v_add_u32 v17, s52, v22
    s_and_b32 s52, s61, 1
    s_mul_i32 s52, s52, 51200
    s_add_u32 s52, s52, 45056
    s_sub_u32 s52, s52, s54
    v_add_u32 v19, s52, v19
    v_add_u32 v20, s52, v20
    v_add_u32 v21, s52, v21
    v_lshlrev_b32 v18, 3, v6
    v_lshl_add_u32 v18, v7, 9, v18
    s_lshl_b32 s52, s61, 2
    v_add_u32 v0, s52, v13
    s_xor_b32 s52, s52, 4
    v_add_u32 v10, s52, v12
    v_mov_b32 v1, 1
    s_mov_b32 s63, 1600000
LW_101:
    ds_read_b32 v2, v12 offset:352
    s_waitcnt lgkmcnt(0)
    v_readfirstlane_b32 s52, v2
    s_nop 1
    s_cmp_ge_u32 s52, 8
    s_cbranch_scc1 LWD_102
    s_sleep 1
    s_sub_u32 s63, s63, 1
    s_cmp_lg_u32 s63, 0
    s_cbranch_scc1 LW_101
LWD_102:
    ds_write_b128 v15, v[72:75] offset:0
    ds_write_b128 v15, v[76:79] offset:1024
    ds_write_b128 v15, v[80:83] offset:2048
    ds_write_b128 v15, v[84:87] offset:3072
    ds_write_b128 v15, v[88:91] offset:4096
    ds_write_b128 v15, v[92:95] offset:5120
    ds_write_b128 v15, v[96:99] offset:6144
    ds_write_b128 v15, v[100:103] offset:7168
    ds_write_b128 v15, v[104:107] offset:8192
    ds_write_b128 v15, v[108:111] offset:9216
    s_waitcnt vmcnt(6)
    ds_add_u32 v13, v1 offset:284
    v_mul_f32 v9, v9, v9
    s_waitcnt vmcnt(0)
    v_lshlrev_b32 v2, 16, v120
    v_lshlrev_b32 v3, 16, v132
    v_and_b32 v4, 0xffff0000, v120
    v_and_b32 v5, 0xffff0000, v132
    v_add_f32 v144, v2, v3
    v_add_f32 v145, v4, v5
    v_lshlrev_b32 v2, 16, v121
    v_lshlrev_b32 v3, 16, v133
    v_and_b32 v4, 0xffff0000, v121
    v_and_b32 v5, 0xffff0000, v133
    v_add_f32 v146, v2, v3
    v_add_f32 v147, v4, v5
    v_lshlrev_b32 v2, 16, v122
    v_lshlrev_b32 v3, 16, v134
    v_and_b32 v4, 0xffff0000, v122
    v_and_b32 v5, 0xffff0000, v134
    v_add_f32 v148, v2, v3
    v_add_f32 v149, v4, v5
    v_lshlrev_b32 v2, 16, v123
    v_lshlrev_b32 v3, 16, v135
    v_and_b32 v4, 0xffff0000, v123
    v_and_b32 v5, 0xffff0000, v135
    v_add_f32 v150, v2, v3
    v_add_f32 v151, v4, v5
    v_lshlrev_b32 v2, 16, v124
    v_lshlrev_b32 v3, 16, v136
    v_and_b32 v4, 0xffff0000, v124
    v_and_b32 v5, 0xffff0000, v136
    v_add_f32 v152, v2, v3
    v_add_f32 v153, v4, v5
    v_lshlrev_b32 v2, 16, v125
    v_lshlrev_b32 v3, 16, v137
    v_and_b32 v4, 0xffff0000, v125
    v_and_b32 v5, 0xffff0000, v137
    v_add_f32 v154, v2, v3
    v_add_f32 v155, v4, v5
    v_lshlrev_b32 v2, 16, v126
    v_lshlrev_b32 v3, 16, v138
    v_and_b32 v4, 0xffff0000, v126
    v_and_b32 v5, 0xffff0000, v138
    v_add_f32 v156, v2, v3
    v_add_f32 v157, v4, v5
    v_lshlrev_b32 v2, 16, v127
    v_lshlrev_b32 v3, 16, v139
    v_and_b32 v4, 0xffff0000, v127
    v_and_b32 v5, 0xffff0000, v139
    v_add_f32 v158, v2, v3
    v_add_f32 v159, v4, v5
    v_lshlrev_b32 v2, 16, v128
    v_lshlrev_b32 v3, 16, v140
    v_and_b32 v4, 0xffff0000, v128
    v_and_b32 v5, 0xffff0000, v140
    v_add_f32 v160, v2, v3
    v_add_f32 v161, v4, v5
    v_lshlrev_b32 v2, 16, v129
    v_lshlrev_b32 v3, 16, v141
    v_and_b32 v4, 0xffff0000, v129
    v_and_b32 v5, 0xffff0000, v141
    v_add_f32 v162, v2, v3
    v_add_f32 v163, v4, v5
    s_mov_b32 s63, 1600000
LW_103:
    ds_read_b32 v2, v12 offset:284
    s_waitcnt lgkmcnt(0)
    v_readfirstlane_b32 s52, v2
    s_nop 1
    s_cmp_ge_u32 s52, 4
    s_cbranch_scc1 LWD_104
    s_sleep 0
    s_sub_u32 s63, s63, 1
    s_cmp_lg_u32 s63, 0
    s_cbranch_scc1 LW_103
LWD_104:
    s_mov_b32 s63, 1600000
LW_105:
    ds_read_b32 v2, v12 offset:352
    s_waitcnt lgkmcnt(0)
    v_readfirstlane_b32 s52, v2
    s_nop 1
    s_cmp_ge_u32 s52, 16
    s_cbranch_scc1 LWD_106
    s_sleep 0
    s_sub_u32 s63, s63, 1
    s_cmp_lg_u32 s63, 0
    s_cbranch_scc1 LW_105
LWD_106:
    buffer_load_dwordx2 v[164:165], v23, s[44:47], s58 offen sc1
    ds_read_b128 v[72:75], v16 offset:0
    ds_read_b128 v[76:79], v16 offset:1024
    ds_read_b128 v[80:83], v16 offset:2048
    ds_read_b128 v[84:87], v16 offset:3072
    ds_read_b128 v[88:91], v16 offset:4096
    ds_read_b128 v[92:95], v16 offset:5120
    ds_read_b128 v[96:99], v16 offset:6144
    ds_read_b128 v[100:103], v16 offset:7168
    ds_read_b128 v[104:107], v16 offset:8192
    ds_read_b128 v[108:111], v16 offset:9216
    s_waitcnt lgkmcnt(9)
    v_add_f32 v24, v24, v72
    v_add_f32 v25, v25, v73
    v_add_f32 v26, v26, v74
    v_add_f32 v27, v27, v75
    v_fma_f32 v24, v24, v9, v144
    v_fma_f32 v25, v25, v9, v145
    v_fma_f32 v26, v26, v9, v146
    v_fma_f32 v27, v27, v9, v147
    s_waitcnt lgkmcnt(8)
    v_add_f32 v28, v28, v76
    v_add_f32 v29, v29, v77
    v_add_f32 v30, v30, v78
    v_add_f32 v31, v31, v79
    v_fma_f32 v28, v28, v9, v148
    v_fma_f32 v29, v29, v9, v149
    v_fma_f32 v30, v30, v9, v150
    v_fma_f32 v31, v31, v9, v151
    s_waitcnt lgkmcnt(7)
    v_add_f32 v32, v32, v80
    v_add_f32 v33, v33, v81
    v_add_f32 v34, v34, v82
    v_add_f32 v35, v35, v83
    v_fma_f32 v32, v32, v9, v152
    v_fma_f32 v33, v33, v9, v153
    v_fma_f32 v34, v34, v9, v154
    v_fma_f32 v35, v35, v9, v155
    s_waitcnt lgkmcnt(6)
    v_add_f32 v36, v36, v84
    v_add_f32 v37, v37, v85
    v_add_f32 v38, v38, v86
    v_add_f32 v39, v39, v87
    v_fma_f32 v36, v36, v9, v156
    v_fma_f32 v37, v37, v9, v157
    v_fma_f32 v38, v38, v9, v158
    v_fma_f32 v39, v39, v9, v159
    s_waitcnt lgkmcnt(5)
    v_add_f32 v40, v40, v88
    v_add_f32 v41, v41, v89
    v_add_f32 v42, v42, v90
    v_add_f32 v43, v43, v91
    v_mul_f32 v40, v40, v9
    v_mul_f32 v41, v41, v9
    v_mul_f32 v42, v42, v9
    v_mul_f32 v43, v43, v9
    s_waitcnt lgkmcnt(4)
    v_add_f32 v44, v44, v92
    v_add_f32 v45, v45, v93
    v_add_f32 v46, v46, v94
    v_add_f32 v47, v47, v95
    v_mul_f32 v44, v44, v9
    v_mul_f32 v45, v45, v9
    v_mul_f32 v46, v46, v9
    v_mul_f32 v47, v47, v9
    s_waitcnt lgkmcnt(3)
    v_add_f32 v48, v48, v96
    v_add_f32 v49, v49, v97
    v_add_f32 v50, v50, v98
    v_add_f32 v51, v51, v99
    v_mul_f32 v48, v48, v9
    v_mul_f32 v49, v49, v9
    v_mul_f32 v50, v50, v9
    v_mul_f32 v51, v51, v9
    s_waitcnt lgkmcnt(2)
    v_add_f32 v52, v52, v100
    v_add_f32 v53, v53, v101
    v_add_f32 v54, v54, v102
    v_add_f32 v55, v55, v103
    v_mul_f32 v52, v52, v9
    v_mul_f32 v53, v53, v9
    v_mul_f32 v54, v54, v9
    v_mul_f32 v55, v55, v9
    s_waitcnt lgkmcnt(1)
    v_add_f32 v56, v56, v104
    v_add_f32 v57, v57, v105
    v_add_f32 v58, v58, v106
    v_add_f32 v59, v59, v107
    v_fma_f32 v56, v56, v9, v160
    v_fma_f32 v57, v57, v9, v161
    v_fma_f32 v58, v58, v9, v162
    v_fma_f32 v59, v59, v9, v163
    s_waitcnt lgkmcnt(0)
    v_add_f32 v60, v60, v108
    v_add_f32 v61, v61, v109
    v_add_f32 v62, v62, v110
    v_add_f32 v63, v63, v111
    v_mul_f32 v60, v60, v9
    v_mul_f32 v61, v61, v9
    v_mul_f32 v62, v62, v9
    v_mul_f32 v63, v63, v9
    ds_read_b64_tr_b16 v[160:161], v21 offset:0
    ds_read_b64_tr_b16 v[162:163], v21 offset:160
    ds_read_b64_tr_b16 v[156:157], v20 offset:0
    ds_read_b64_tr_b16 v[158:159], v20 offset:160
    ds_read_b64_tr_b16 v[152:153], v19 offset:0
    ds_read_b64_tr_b16 v[154:155], v19 offset:160
    s_waitcnt vmcnt(0)
    v_cmp_ne_u64 vcc, s[30:31], v[164:165]
    s_nop 1
    s_cmp_eq_u64 vcc, 0
    s_cbranch_scc1 G_OOK
    s_mov_b32 s63, 200000
POLL_107:
    buffer_load_dwordx2 v[164:165], v23, s[44:47], s58 offen sc1
    s_waitcnt vmcnt(0)
    v_cmp_ne_u64 vcc, s[30:31], v[164:165]
    s_nop 1
    s_cmp_eq_u64 vcc, 0
    s_cbranch_scc1 POLLD_108
    s_sleep 2
    s_sub_u32 s63, s63, 1
    s_cmp_lg_u32 s63, 0
    s_cbranch_scc1 POLL_107
POLLD_108:
G_OOK:
    buffer_load_dwordx4 v[72:75], v22, s[44:47], s57 offen offset:0 sc1
    buffer_load_dwordx4 v[76:79], v22, s[44:47], s57 offen offset:1024 sc1
    buffer_load_dwordx4 v[80:83], v22, s[44:47], s57 offen offset:2048 sc1
    buffer_load_dwordx4 v[84:87], v22, s[44:47], s57 offen offset:3072 sc1
    s_add_u32 s57, s57, 4096
    buffer_load_dwordx2 v[88:89], v18, s[44:47], s57 offen offset:0 sc1
    buffer_load_dwordx2 v[90:91], v18, s[44:47], s57 offen offset:256 sc1
    buffer_load_dwordx4 v[92:95], v22, s[44:47], s57 offen offset:1024 sc1
    ds_read_b64_tr_b16 v[2:3], v21 offset:2560
    ds_read_b64_tr_b16 v[4:5], v21 offset:2720
    ds_read_b64_tr_b16 v[164:165], v20 offset:2560
    ds_read_b64_tr_b16 v[166:167], v20 offset:2720
    ds_read_b64_tr_b16 v[6:7], v19 offset:2560
    ds_read_b64_tr_b16 v[8:9], v19 offset:2720
    s_waitcnt vmcnt(6)
    s_waitcnt lgkmcnt(10)
    v_mfma_f32_32x32x16_bf16 v[56:71], v[160:163], v[72:75], v[56:71]
    ds_read_b64_tr_b16 v[160:161], v21 offset:5120
    ds_read_b64_tr_b16 v[162:163], v21 offset:5280
    buffer_load_dwordx4 v[96:99], v22, s[44:47], s57 offen offset:2048 sc1
    s_waitcnt lgkmcnt(10)
    v_mfma_f32_32x32x16_bf16 v[40:55], v[156:159], v[72:75], v[40:55]
    ds_read_b64_tr_b16 v[156:157], v20 offset:5120
    ds_read_b64_tr_b16 v[158:159], v20 offset:5280
    s_waitcnt lgkmcnt(10)
    v_mfma_f32_32x32x16_bf16 v[24:39], v[152:155], v[72:75], v[24:39]
    ds_read_b64_tr_b16 v[152:153], v19 offset:5120
    ds_read_b64_tr_b16 v[154:155], v19 offset:5280
    s_waitcnt vmcnt(6)
    s_waitcnt lgkmcnt(10)
    v_mfma_f32_32x32x16_bf16 v[56:71], v[2:5], v[76:79], v[56:71]
    ds_read_b64_tr_b16 v[2:3], v21 offset:7680
    ds_read_b64_tr_b16 v[4:5], v21 offset:7840
    buffer_load_dwordx4 v[100:103], v22, s[44:47], s57 offen offset:3072 sc1
    s_waitcnt lgkmcnt(10)
    v_mfma_f32_32x32x16_bf16 v[40:55], v[164:167], v[76:79], v[40:55]
    ds_read_b64_tr_b16 v[164:165], v20 offset:7680
    ds_read_b64_tr_b16 v[166:167], v20 offset:7840
    s_waitcnt lgkmcnt(10)
    v_mfma_f32_32x32x16_bf16 v[24:39], v[6:9], v[76:79], v[24:39]
    ds_read_b64_tr_b16 v[6:7], v19 offset:7680
    ds_read_b64_tr_b16 v[8:9], v19 offset:7840
    s_waitcnt vmcnt(6)
    s_waitcnt lgkmcnt(10)
    v_mfma_f32_32x32x16_bf16 v[56:71], v[160:163], v[80:83], v[56:71]
    ds_read_b64_tr_b16 v[160:161], v21 offset:10240
    ds_read_b64_tr_b16 v[162:163], v21 offset:10400
    s_add_u32 s57, s57, 4096
    buffer_load_dwordx4 v[104:107], v22, s[44:47], s57 offen offset:0 sc1
    s_waitcnt lgkmcnt(10)
    v_mfma_f32_32x32x16_bf16 v[40:55], v[156:159], v[80:83], v[40:55]
    ds_read_b64_tr_b16 v[156:157], v20 offset:10240
    ds_read_b64_tr_b16 v[158:159], v20 offset:10400
    s_waitcnt lgkmcnt(10)
    v_mfma_f32_32x32x16_bf16 v[24:39], v[152:155], v[80:83], v[24:39]
    ds_read_b64_tr_b16 v[152:153], v19 offset:10240
    ds_read_b64_tr_b16 v[154:155], v19 offset:10400
    s_waitcnt vmcnt(6)
    s_waitcnt lgkmcnt(10)
    v_mfma_f32_32x32x16_bf16 v[56:71], v[2:5], v[84:87], v[56:71]
    ds_read_b64_tr_b16 v[2:3], v21 offset:12800
    ds_read_b64_tr_b16 v[4:5], v21 offset:12960
    buffer_load_dwordx2 v[108:109], v18, s[44:47], s57 offen offset:1024 sc1
    buffer_load_dwordx2 v[110:111], v18, s[44:47], s57 offen offset:1280 sc1
    s_waitcnt lgkmcnt(10)
    v_mfma_f32_32x32x16_bf16 v[40:55], v[164:167], v[84:87], v[40:55]
    ds_read_b64_tr_b16 v[164:165], v20 offset:12800
    ds_read_b64_tr_b16 v[166:167], v20 offset:12960
    s_waitcnt lgkmcnt(10)
    v_mfma_f32_32x32x16_bf16 v[24:39], v[6:9], v[84:87], v[24:39]
    ds_read_b64_tr_b16 v[6:7], v19 offset:12800
    ds_read_b64_tr_b16 v[8:9], v19 offset:12960
    s_waitcnt vmcnt(6)
    s_waitcnt lgkmcnt(10)
    v_mfma_f32_32x32x16_bf16 v[56:71], v[160:163], v[88:91], v[56:71]
    ds_read_b64_tr_b16 v[160:161], v21 offset:15360
    ds_read_b64_tr_b16 v[162:163], v21 offset:15520
    buffer_load_dwordx4 v[112:115], v22, s[44:47], s57 offen offset:2048 sc1
    s_waitcnt lgkmcnt(10)
    v_mfma_f32_32x32x16_bf16 v[40:55], v[156:159], v[88:91], v[40:55]
    ds_read_b64_tr_b16 v[156:157], v20 offset:15360
    ds_read_b64_tr_b16 v[158:159], v20 offset:15520
    s_waitcnt lgkmcnt(10)
    v_mfma_f32_32x32x16_bf16 v[24:39], v[152:155], v[88:91], v[24:39]
    ds_read_b64_tr_b16 v[152:153], v19 offset:15360
    ds_read_b64_tr_b16 v[154:155], v19 offset:15520
    s_waitcnt vmcnt(6)
    s_waitcnt lgkmcnt(10)
    v_mfma_f32_32x32x16_bf16 v[56:71], v[2:5], v[92:95], v[56:71]
    ds_read_b64_tr_b16 v[2:3], v21 offset:17920
    ds_read_b64_tr_b16 v[4:5], v21 offset:18080
    buffer_load_dwordx4 v[116:119], v22, s[44:47], s57 offen offset:3072 sc1
    s_waitcnt lgkmcnt(10)
    v_mfma_f32_32x32x16_bf16 v[40:55], v[164:167], v[92:95], v[40:55]
    ds_read_b64_tr_b16 v[164:165], v20 offset:17920
    ds_read_b64_tr_b16 v[166:167], v20 offset:18080
    s_waitcnt lgkmcnt(10)
    v_mfma_f32_32x32x16_bf16 v[24:39], v[6:9], v[92:95], v[24:39]
    ds_read_b64_tr_b16 v[6:7], v19 offset:17920
    ds_read_b64_tr_b16 v[8:9], v19 offset:18080
    s_waitcnt vmcnt(6)
    s_waitcnt lgkmcnt(10)
    v_mfma_f32_32x32x16_bf16 v[56:71], v[160:163], v[96:99], v[56:71]
    ds_read_b64_tr_b16 v[160:161], v21 offset:20480
    ds_read_b64_tr_b16 v[162:163], v21 offset:20640
    s_add_u32 s57, s57, 4096
    buffer_load_dwordx4 v[120:123], v22, s[44:47], s57 offen offset:0 sc1
    s_waitcnt lgkmcnt(10)
    v_mfma_f32_32x32x16_bf16 v[40:55], v[156:159], v[96:99], v[40:55]
    ds_read_b64_tr_b16 v[156:157], v20 offset:20480
    ds_read_b64_tr_b16 v[158:159], v20 offset:20640
    s_waitcnt lgkmcnt(10)
    v_mfma_f32_32x32x16_bf16 v[24:39], v[152:155], v[96:99], v[24:39]
    ds_read_b64_tr_b16 v[152:153], v19 offset:20480
    ds_read_b64_tr_b16 v[154:155], v19 offset:20640
    s_waitcnt vmcnt(6)
    s_waitcnt lgkmcnt(10)
    v_mfma_f32_32x32x16_bf16 v[56:71], v[2:5], v[100:103], v[56:71]
    ds_read_b64_tr_b16 v[2:3], v21 offset:23040
    ds_read_b64_tr_b16 v[4:5], v21 offset:23200
    buffer_load_dwordx4 v[124:127], v22, s[44:47], s57 offen offset:1024 sc1
    s_waitcnt lgkmcnt(10)
    v_mfma_f32_32x32x16_bf16 v[40:55], v[164:167], v[100:103], v[40:55]
    ds_read_b64_tr_b16 v[164:165], v20 offset:23040
    ds_read_b64_tr_b16 v[166:167], v20 offset:23200
    s_waitcnt lgkmcnt(10)
    v_mfma_f32_32x32x16_bf16 v[24:39], v[6:9], v[100:103], v[24:39]
    ds_read_b64_tr_b16 v[6:7], v19 offset:23040
    ds_read_b64_tr_b16 v[8:9], v19 offset:23200
    s_waitcnt vmcnt(6)
    s_waitcnt lgkmcnt(10)
    v_mfma_f32_32x32x16_bf16 v[56:71], v[160:163], v[104:107], v[56:71]
    ds_read_b64_tr_b16 v[160:161], v21 offset:25600
    ds_read_b64_tr_b16 v[162:163], v21 offset:25760
    buffer_load_dwordx2 v[128:129], v18, s[44:47], s57 offen offset:2048 sc1
    buffer_load_dwordx2 v[130:131], v18, s[44:47], s57 offen offset:2304 sc1
    s_waitcnt lgkmcnt(10)
    v_mfma_f32_32x32x16_bf16 v[40:55], v[156:159], v[104:107], v[40:55]
    ds_read_b64_tr_b16 v[156:157], v20 offset:25600
    ds_read_b64_tr_b16 v[158:159], v20 offset:25760
    s_waitcnt lgkmcnt(10)
    v_mfma_f32_32x32x16_bf16 v[24:39], v[152:155], v[104:107], v[24:39]
    ds_read_b64_tr_b16 v[152:153], v19 offset:25600
    ds_read_b64_tr_b16 v[154:155], v19 offset:25760
    s_waitcnt vmcnt(6)
    s_waitcnt lgkmcnt(10)
    v_mfma_f32_32x32x16_bf16 v[56:71], v[2:5], v[108:111], v[56:71]
    ds_read_b64_tr_b16 v[2:3], v21 offset:28160
    ds_read_b64_tr_b16 v[4:5], v21 offset:28320
    buffer_load_dwordx4 v[132:135], v22, s[44:47], s57 offen offset:3072 sc1
    s_waitcnt lgkmcnt(10)
    v_mfma_f32_32x32x16_bf16 v[40:55], v[164:167], v[108:111], v[40:55]
    ds_read_b64_tr_b16 v[164:165], v20 offset:28160
    ds_read_b64_tr_b16 v[166:167], v20 offset:28320
    s_waitcnt lgkmcnt(10)
    v_mfma_f32_32x32x16_bf16 v[24:39], v[6:9], v[108:111], v[24:39]
    ds_read_b64_tr_b16 v[6:7], v19 offset:28160
    ds_read_b64_tr_b16 v[8:9], v19 offset:28320
    s_waitcnt vmcnt(6)
    s_waitcnt lgkmcnt(10)
    v_mfma_f32_32x32x16_bf16 v[56:71], v[160:163], v[112:115], v[56:71]
    ds_read_b64_tr_b16 v[160:161], v21 offset:30720
    ds_read_b64_tr_b16 v[162:163], v21 offset:30880
    s_add_u32 s57, s57, 4096
    buffer_load_dwordx4 v[136:139], v22, s[44:47], s57 offen offset:0 sc1
    s_waitcnt lgkmcnt(10)
    v_mfma_f32_32x32x16_bf16 v[40:55], v[156:159], v[112:115], v[40:55]
    ds_read_b64_tr_b16 v[156:157], v20 offset:30720
    ds_read_b64_tr_b16 v[158:159], v20 offset:30880
    s_waitcnt lgkmcnt(10)
    v_mfma_f32_32x32x16_bf16 v[24:39], v[152:155], v[112:115], v[24:39]
    ds_read_b64_tr_b16 v[152:153], v19 offset:30720
    ds_read_b64_tr_b16 v[154:155], v19 offset:30880
    s_waitcnt vmcnt(6)
    s_waitcnt lgkmcnt(10)
    v_mfma_f32_32x32x16_bf16 v[56:71], v[2:5], v[116:119], v[56:71]
    ds_read_b64_tr_b16 v[2:3], v21 offset:33280
    ds_read_b64_tr_b16 v[4:5], v21 offset:33440
    buffer_load_dwordx4 v[140:143], v22, s[44:47], s57 offen offset:1024 sc1
    s_waitcnt lgkmcnt(10)
    v_mfma_f32_32x32x16_bf16 v[40:55], v[164:167], v[116:119], v[40:55]
    ds_read_b64_tr_b16 v[164:165], v20 offset:33280
    ds_read_b64_tr_b16 v[166:167], v20 offset:33440
    s_waitcnt lgkmcnt(10)
    v_mfma_f32_32x32x16_bf16 v[24:39], v[6:9], v[116:119], v[24:39]
    ds_read_b64_tr_b16 v[6:7], v19 offset:33280
    ds_read_b64_tr_b16 v[8:9], v19 offset:33440
    s_waitcnt vmcnt(6)
    s_waitcnt lgkmcnt(10)
    v_mfma_f32_32x32x16_bf16 v[56:71], v[160:163], v[120:123], v[56:71]
    ds_read_b64_tr_b16 v[160:161], v21 offset:35840
    ds_read_b64_tr_b16 v[162:163], v21 offset:36000
    buffer_load_dwordx4 v[144:147], v22, s[44:47], s57 offen offset:2048 sc1
    s_waitcnt lgkmcnt(10)
    v_mfma_f32_32x32x16_bf16 v[40:55], v[156:159], v[120:123], v[40:55]
    ds_read_b64_tr_b16 v[156:157], v20 offset:35840
    ds_read_b64_tr_b16 v[158:159], v20 offset:36000
    s_waitcnt lgkmcnt(10)
    v_mfma_f32_32x32x16_bf16 v[24:39], v[152:155], v[120:123], v[24:39]
    ds_read_b64_tr_b16 v[152:153], v19 offset:35840
    ds_read_b64_tr_b16 v[154:155], v19 offset:36000
    s_waitcnt vmcnt(6)
    s_waitcnt lgkmcnt(10)
    v_mfma_f32_32x32x16_bf16 v[56:71], v[2:5], v[124:127], v[56:71]
    ds_read_b64_tr_b16 v[2:3], v21 offset:38400
    ds_read_b64_tr_b16 v[4:5], v21 offset:38560
    buffer_load_dwordx2 v[148:149], v18, s[44:47], s57 offen offset:3072 sc1
    buffer_load_dwordx2 v[150:151], v18, s[44:47], s57 offen offset:3328 sc1
    s_waitcnt lgkmcnt(10)
    v_mfma_f32_32x32x16_bf16 v[40:55], v[164:167], v[124:127], v[40:55]
    ds_read_b64_tr_b16 v[164:165], v20 offset:38400
    ds_read_b64_tr_b16 v[166:167], v20 offset:38560
    s_waitcnt lgkmcnt(10)
    v_mfma_f32_32x32x16_bf16 v[24:39], v[6:9], v[124:127], v[24:39]
    ds_read_b64_tr_b16 v[6:7], v19 offset:38400
    ds_read_b64_tr_b16 v[8:9], v19 offset:38560
    s_waitcnt vmcnt(6)
    s_waitcnt lgkmcnt(10)
    v_mfma_f32_32x32x16_bf16 v[56:71], v[160:163], v[128:131], v[56:71]
    ds_read_b64_tr_b16 v[160:161], v21 offset:40960
    ds_read_b64_tr_b16 v[162:163], v21 offset:41120
    s_waitcnt lgkmcnt(10)
    v_mfma_f32_32x32x16_bf16 v[40:55], v[156:159], v[128:131], v[40:55]
    ds_read_b64_tr_b16 v[156:157], v20 offset:40960
    ds_read_b64_tr_b16 v[158:159], v20 offset:41120
    s_waitcnt lgkmcnt(10)
    v_mfma_f32_32x32x16_bf16 v[24:39], v[152:155], v[128:131], v[24:39]
    ds_read_b64_tr_b16 v[152:153], v19 offset:40960
    ds_read_b64_tr_b16 v[154:155], v19 offset:41120
    s_waitcnt vmcnt(5)
    s_waitcnt lgkmcnt(10)
    v_mfma_f32_32x32x16_bf16 v[56:71], v[2:5], v[132:135], v[56:71]
    ds_read_b64_tr_b16 v[2:3], v21 offset:43520
    ds_read_b64_tr_b16 v[4:5], v21 offset:43680
    s_waitcnt lgkmcnt(10)
    v_mfma_f32_32x32x16_bf16 v[40:55], v[164:167], v[132:135], v[40:55]
    ds_read_b64_tr_b16 v[164:165], v20 offset:43520
    ds_read_b64_tr_b16 v[166:167], v20 offset:43680
    s_waitcnt lgkmcnt(10)
    v_mfma_f32_32x32x16_bf16 v[24:39], v[6:9], v[132:135], v[24:39]
    ds_read_b64_tr_b16 v[6:7], v19 offset:43520
    ds_read_b64_tr_b16 v[8:9], v19 offset:43680
    s_waitcnt vmcnt(4)
    s_waitcnt lgkmcnt(10)
    v_mfma_f32_32x32x16_bf16 v[56:71], v[160:163], v[136:139], v[56:71]
    ds_read_b64_tr_b16 v[160:161], v21 offset:46080
    ds_read_b64_tr_b16 v[162:163], v21 offset:46240
    s_waitcnt lgkmcnt(10)
    v_mfma_f32_32x32x16_bf16 v[40:55], v[156:159], v[136:139], v[40:55]
    ds_read_b64_tr_b16 v[156:157], v20 offset:46080
    ds_read_b64_tr_b16 v[158:159], v20 offset:46240
    s_waitcnt lgkmcnt(10)
    v_mfma_f32_32x32x16_bf16 v[24:39], v[152:155], v[136:139], v[24:39]
    ds_read_b64_tr_b16 v[152:153], v19 offset:46080
    ds_read_b64_tr_b16 v[154:155], v19 offset:46240
    s_waitcnt vmcnt(3)
    s_waitcnt lgkmcnt(10)
    v_mfma_f32_32x32x16_bf16 v[56:71], v[2:5], v[140:143], v[56:71]
    ds_read_b64_tr_b16 v[2:3], v21 offset:48640
    ds_read_b64_tr_b16 v[4:5], v21 offset:48800
    s_waitcnt lgkmcnt(10)
    v_mfma_f32_32x32x16_bf16 v[40:55], v[164:167], v[140:143], v[40:55]
    ds_read_b64_tr_b16 v[164:165], v20 offset:48640
    ds_read_b64_tr_b16 v[166:167], v20 offset:48800
    s_waitcnt lgkmcnt(10)
    v_mfma_f32_32x32x16_bf16 v[24:39], v[6:9], v[140:143], v[24:39]
    ds_read_b64_tr_b16 v[6:7], v19 offset:48640
    ds_read_b64_tr_b16 v[8:9], v19 offset:48800
    s_waitcnt vmcnt(2)
    s_waitcnt lgkmcnt(10)
    v_mfma_f32_32x32x16_bf16 v[56:71], v[160:163], v[144:147], v[56:71]
    s_waitcnt lgkmcnt(8)
    v_mfma_f32_32x32x16_bf16 v[40:55], v[156:159], v[144:147], v[40:55]
    s_waitcnt lgkmcnt(6)
    v_mfma_f32_32x32x16_bf16 v[24:39], v[152:155], v[144:147], v[24:39]
    s_waitcnt vmcnt(0)
    s_waitcnt lgkmcnt(4)
    v_mfma_f32_32x32x16_bf16 v[56:71], v[2:5], v[148:151], v[56:71]
    s_waitcnt lgkmcnt(2)
    v_mfma_f32_32x32x16_bf16 v[40:55], v[164:167], v[148:151], v[40:55]
    s_waitcnt lgkmcnt(0)
    v_mfma_f32_32x32x16_bf16 v[24:39], v[6:9], v[148:151], v[24:39]
    s_nop 7
    s_nop 1
    ds_write_b128 v16, v[60:63] offset:4096
    ds_write_b128 v16, v[40:43] offset:0
    ds_write_b128 v16, v[44:47] offset:1024
    ds_write_b128 v16, v[48:51] offset:2048
    ds_write_b128 v16, v[52:55] offset:3072
    ds_add_u32 v0, v1 offset:356
    s_mov_b32 s63, 1600000
G_FW:
    ds_read_b32 v2, v10 offset:356
    s_waitcnt lgkmcnt(0)
    v_readfirstlane_b32 s52, v2
    s_sub_u32 s63, s63, 1
    s_cmp_eq_u32 s63, 0
    s_cbranch_scc1 G_FD
    s_cmp_eq_u32 s52, 0
    s_cbranch_scc1 G_FW
G_FD:
    ds_read_b128 v[72:75], v17 offset:0
    ds_read_b128 v[76:79], v17 offset:1024
    ds_read_b128 v[80:83], v17 offset:2048
    ds_read_b128 v[84:87], v17 offset:3072
    ds_read_b128 v[88:91], v17 offset:4096
    s_waitcnt lgkmcnt(4)
    v_add_f32 v24, v24, v72
    v_add_f32 v25, v25, v73
    v_add_f32 v26, v26, v74
    v_add_f32 v27, v27, v75
    v_cvt_pk_bf16_f32 v120, v24, v25
    v_cvt_pk_bf16_f32 v121, v26, v27
    s_waitcnt lgkmcnt(3)
    v_add_f32 v28, v28, v76
    v_add_f32 v29, v29, v77
    v_add_f32 v30, v30, v78
    v_add_f32 v31, v31, v79
    v_cvt_pk_bf16_f32 v122, v28, v29
    v_cvt_pk_bf16_f32 v123, v30, v31
    buffer_store_dwordx4 v[120:123], v14, s[36:39], s60 offen offset:0
    s_waitcnt lgkmcnt(2)
    v_add_f32 v32, v32, v80
    v_add_f32 v33, v33, v81
    v_add_f32 v34, v34, v82
    v_add_f32 v35, v35, v83
    v_cvt_pk_bf16_f32 v124, v32, v33
    v_cvt_pk_bf16_f32 v125, v34, v35
    s_waitcnt lgkmcnt(1)
    v_add_f32 v36, v36, v84
    v_add_f32 v37, v37, v85
    v_add_f32 v38, v38, v86
    v_add_f32 v39, v39, v87
    v_cvt_pk_bf16_f32 v126, v36, v37
    v_cvt_pk_bf16_f32 v127, v38, v39
    buffer_store_dwordx4 v[124:127], v14, s[36:39], s60 offen offset:16
    s_waitcnt lgkmcnt(0)
    v_add_f32 v56, v56, v88
    v_add_f32 v57, v57, v89
    v_add_f32 v58, v58, v90
    v_add_f32 v59, v59, v91
    v_cvt_pk_bf16_f32 v128, v56, v57
    v_cvt_pk_bf16_f32 v129, v58, v59
    buffer_store_dwordx2 v[128:129], v11, s[36:39], s60 offen offset:128
F_END:
    s_endpgm
F_LAST:
.section .rodata,"a"
.p2align 6
.amdhsa_kernel parallel_sum__grouped_kv_mqa__dense_activation_squared_relu__prompt_kernel
  .amdhsa_next_free_vgpr 168
  .amdhsa_next_free_sgpr 80
  .amdhsa_accum_offset 168
  .amdhsa_group_segment_fixed_size 0
  .amdhsa_kernarg_size 104
  .amdhsa_user_sgpr_count 2
  .amdhsa_user_sgpr_kernarg_segment_ptr 1
  .amdhsa_system_sgpr_workgroup_id_x 1
.end_amdhsa_kernel
```
